```python
import torch

def _softmax(x, axis=-1):
    return torch.softmax(x, dim=axis)
def _gelu(x):
    return torch.nn.functional.gelu(x, approximate="tanh")
def _silu(x):
    return torch.nn.functional.silu(x)
def _sigmoid(x):
    return torch.sigmoid(x)
def _layernorm(x, axis=-1, eps=1e-5):
    m = x.mean(dim=axis, keepdim=True)
    v = x.var(dim=axis, keepdim=True, unbiased=False)
    return (x - m) / torch.sqrt(v + eps)
def _scatter_add(tgt, idx, src, axis=0):
    return tgt.clone().index_add_(axis, idx, src)
def _segment_sum(src, seg, n):
    out = torch.zeros((n,) + src.shape[1:], dtype=src.dtype)
    return out.index_add_(0, seg, src)
def _pad(x, pw):
    flat = tuple(v for pair in reversed(pw) for v in pair)
    return torch.nn.functional.pad(x, flat)

kernel_name = 'gather_scatter__edge_featured_mpnn_gatedgcn__graph'

def setup_inputs():

    _w = (lambda a: (lambda t: t.to(torch.bfloat16) if t.is_floating_point() else t)(torch.as_tensor(a)))
    N, deg, D, De = 25000, 32, 64, max(4, 1)
    E = N * deg
    return {
        "x": _w((lambda *s: torch.randn(*s, dtype=torch.bfloat16) * 0.8)(N, D)),
        "e_attr": _w((lambda *s: torch.randn(*s, dtype=torch.bfloat16) * 0.8)(E, De)),
        "src": _w((lambda lo, hi, *s: torch.randint(lo, hi, s))(0, N, E).to(torch.int64)),
        "dst": _w((lambda lo, hi, *s: torch.randint(lo, hi, s))(0, N, E).to(torch.int64)),
        "w_a": _w((lambda *s: torch.randn(*s, dtype=torch.bfloat16) * 0.8)(D, D)),
        "w_b": _w((lambda *s: torch.randn(*s, dtype=torch.bfloat16) * 0.8)(D, D)),
        "w_c": _w((lambda *s: torch.randn(*s, dtype=torch.bfloat16) * 0.8)(De, D)),
        "w_u": _w((lambda *s: torch.randn(*s, dtype=torch.bfloat16) * 0.05)(D, D)),
        "w_v": _w((lambda *s: torch.randn(*s, dtype=torch.bfloat16) * 0.05)(D, D)),
    }

def reference(x, e_attr, src, dst, w_a, w_b, w_c, w_u, w_v):
    N, D = x.shape
    hv = x @ w_v
    g = x[dst] @ w_a + x[src] @ w_b + e_attr @ w_c
    eta = _sigmoid(g)
    denom = _segment_sum(eta, dst, N) + 1e-6
    eta_n = eta / denom[dst]
    agg = _segment_sum(eta_n * hv[src], dst, N)
    z = x @ w_u + agg
    relu_z = torch.where(z > 0, z, 0 * z)
    return x + relu_z
```

```asm
; @launch grid=(256,1,1) block=(512,1,1) lds=162352
.amdgcn_target "amdgcn-amd-amdhsa--gfx950"
.text
.globl gather_scatter__edge_featured_mpnn_gatedgcn__graph_kernel
.p2align 8
.type gather_scatter__edge_featured_mpnn_gatedgcn__graph_kernel,@function
gather_scatter__edge_featured_mpnn_gatedgcn__graph_kernel:
    s_cmp_ge_u32 s2, 256
    s_cbranch_scc1 FK_END
    s_load_dwordx16 s[68:83], s[0:1], 0
    s_load_dwordx8 s[84:91], s[0:1], 64
    s_memrealtime s[94:95]
    v_lshrrev_b32 v2, 6, v0
    v_and_b32 v1, 63, v0
    v_readfirstlane_b32 s3, v2
    s_mul_i32 s26, s2, 782
    v_add_u32 v4, s26, v0
    v_lshlrev_b32 v5, 4, v4
    v_lshlrev_b32 v6, 5, v4
    v_add_u32 v7, 512, v4
    v_cmp_gt_u32 vcc, 200000, v4
    s_mov_b64 s[40:41], vcc
    v_cmp_gt_u32 vcc, 270, v0
    s_mov_b64 s[42:43], vcc
    v_cmp_gt_u32 vcc, 200000, v7
    s_and_b64 s[42:43], s[42:43], vcc
    v_add_u32 v8, 8192, v5
    v_add_u32 v9, 16384, v6
    v_lshlrev_b32 v23, 4, v0
    v_mov_b32 v12, 0
    v_mov_b32 v13, 0
    v_mov_b32 v14, 0
    v_mov_b32 v15, 0
    v_lshlrev_b32 v62, 3, v1
    s_cmp_lg_u32 s3, 7
    s_cbranch_scc1 FK_N7
    v_mov_b32 v10, 0x10000
    v_mov_b32 v11, 0x10000
    v_add_u32 v22, 74000, v62
    ds_write_b64 v22, v[10:11]
FK_N7:
    s_cmp_lg_u32 s3, 6
    s_cbranch_scc1 FK_N6
    v_lshlrev_b32 v11, 4, v1
    ds_write_b128 v11, v[12:15] offset:37536
    ds_write_b128 v11, v[12:15] offset:38560
FK_N6:
    s_lshl_b32 s30, s3, 6
    s_add_u32 s30, s30, 74512
    v_lshl_add_u32 v11, v1, 2, s30
    v_add_u32 v22, 72320, v23
    v_cmp_gt_u32 vcc, 105, v0
    s_mov_b64 exec, 0xffff
    ds_write_b32 v11, v12
    s_and_b64 exec, vcc, vcc
    s_cbranch_execz FK_NOZ
    ds_write_b128 v22, v[12:15]
FK_NOZ:
    s_mov_b64 exec, -1
    s_waitcnt lgkmcnt(0)
    s_barrier
    s_mov_b64 s[56:57], s[70:71]
    s_mov_b64 exec, s[42:43]
    global_load_dwordx4 v[132:135], v8, s[74:75]
    global_load_dwordx4 v[140:143], v8, s[72:73]
    global_load_dwordx4 v[152:155], v9, s[56:57]
    global_load_dwordx4 v[156:159], v9, s[56:57] offset:16
    s_mov_b64 exec, -1
    v_mov_b32 v8, v5
    v_mov_b32 v9, v6
    s_or_b32 s30, s2, s3
    s_cbranch_scc1 FK_N0
    v_mov_b32 v12, s94
    v_mov_b32 v13, s95
    v_mov_b32 v4, 0
    s_mov_b64 exec, 1
    global_store_dwordx2 v4, v[12:13], s[88:89] sc0 sc1
    s_mov_b64 exec, -1
FK_N0:
    s_and_b32 s70, s2, 7
    s_lshl_b32 s70, s70, 5
    s_lshr_b32 s30, s2, 3
    s_or_b32 s70, s70, s30
    s_mov_b32 s4, s68
    s_and_b32 s5, s69, 0xffff
    s_mov_b32 s6, 3200000
    s_mov_b32 s7, 0x20000
    s_lshr_b32 s27, s3, 1
    s_and_b32 s28, s3, 1
    v_lshrrev_b32 v12, 3, v1
    v_and_b32 v13, 7, v1
    v_lshrrev_b32 v14, 2, v12
    v_xor_b32 v13, v13, v14
    v_lshlrev_b32 v13, 4, v13
    s_mul_i32 s29, s70, 98
    s_lshl_b32 s30, s27, 5
    s_add_u32 s29, s29, s30
    s_lshl_b32 s30, s28, 1
    s_add_u32 s29, s29, s30
    s_lshl_b32 s29, s29, 7
    v_lshlrev_b32 v14, 9, v12
    v_add_u32 v14, s29, v14
    s_lshl_b32 s30, s28, 6
    v_xor_b32 v15, s30, v13
    v_add_u32 v20, v14, v15
    v_xor_b32 v15, 32, v15
    v_add3_u32 v21, v14, v15, 64
    v_add_u32 v21, 64, v21
    v_lshlrev_b32 v5, 4, v1
    v_mov_b32 v7, 1
    s_mul_i32 s26, s2, 37536
    s_add_u32 s26, s26, 2097152
    s_add_u32 s32, s90, s26
    s_addc_u32 s33, s91, 0
    s_and_b32 s33, s33, 0xffff
    s_mov_b32 s34, 37536
    s_mov_b32 s35, 0x20000
    s_sub_u32 s96, s68, 3072
    s_subb_u32 s97, s69, 0
    s_and_b32 s97, s97, 0xffff
    s_mov_b32 s98, 3203072
    s_mov_b32 s99, 0x20000
    v_lshrrev_b32 v233, 3, v1
    v_and_b32 v234, 7, v1
    v_lshrrev_b32 v232, 2, v233
    v_xor_b32 v234, v234, v232
    v_lshlrev_b32 v234, 4, v234
    s_mov_b32 s8, s86
    s_and_b32 s9, s87, 0xffff
    s_mov_b32 s10, 3200000
    s_mov_b32 s11, 0x20000
    s_mov_b32 s16, 0
    s_mov_b32 s17, 0xffff
    s_mov_b32 s18, 0
    s_mov_b32 s67, 0
    v_add_u32 v24, 3072, v234
    v_xor_b32 v25, 32, v234
    v_add_u32 v25, 2048, v25
    v_xor_b32 v26, 64, v234
    v_add_u32 v26, 1024, v26
    v_xor_b32 v27, 96, v234
    v_and_b32 v59, 1, v233
    v_lshrrev_b32 v60, 1, v233
    v_lshlrev_b32 v60, 4, v60
    v_add_u32 v60, 114720, v60
    v_and_b32 v2, 31, v1
    v_lshrrev_b32 v3, 5, v1
    v_lshlrev_b32 v36, 2, v2
    v_and_b32 v224, 3, v2
    v_lshrrev_b32 v231, 2, v2
    v_lshlrev_b32 v225, 10, v224
    v_lshl_add_u32 v225, v231, 7, v225
    v_lshrrev_b32 v226, 2, v231
    v_lshl_or_b32 v226, v224, 1, v226
    v_xor_b32 v226, v226, v3
    v_lshl_add_u32 v225, v226, 4, v225
    s_lshl_b32 s24, s3, 12
    s_add_u32 s24, s24, 129584
    v_add_u32 v28, s24, v225
    v_xor_b32 v226, 32, v225
    v_add_u32 v29, s24, v226
    v_xor_b32 v226, 64, v225
    v_add_u32 v30, s24, v226
    v_xor_b32 v226, 96, v225
    v_add_u32 v31, s24, v226
    v_and_b32 v56, 1, v231
    v_lshrrev_b32 v227, 1, v231
    v_lshl_add_u32 v228, v227, 2, v224
    v_lshlrev_b32 v33, 6, v3
    v_sub_u32 v33, 128, v33
    v_lshrrev_b32 v57, 2, v33
    v_lshrrev_b32 v229, 4, v33
    v_mul_u32_u24 v230, 29712, v3
    v_mad_u32_u24 v58, v228, v229, v230
    v_add_u32 v58, 85008, v58
    v_cmp_eq_u32 s[36:37], v56, v3
    v_mov_b32 v228, 7
    v_mov_b32 v229, 0x3f80
    v_cndmask_b32_e64 v227, v228, v227, s[36:37]
    v_and_b32 v228, 1, v227
    v_lshlrev_b32 v228, 4, v228
    v_lshlrev_b32 v229, v228, v229
    v_lshrrev_b32 v227, 1, v227
    v_cmp_eq_u32 s[60:61], 0, v227
    v_cmp_eq_u32 s[62:63], 1, v227
    v_mul_u32_u24 v61, 12, v1
    v_mov_b32 v17, 73984
    v_cndmask_b32_e64 v48, 0, v229, s[60:61]
    v_cndmask_b32_e64 v49, 0, v229, s[62:63]
    s_lshl_b32 s31, s3, 5
    v_add_u32 v224, s31, v2
    v_mul_u32_u24 v63, 37536, v224
    v_add_u32 v63, 2097152, v63
    v_lshlrev_b32 v16, 12, v224
    v_lshl_add_u32 v16, v3, 11, v16
    v_and_b32 v227, 15, v1
    v_lshrrev_b32 v228, 2, v227
    v_lshlrev_b32 v228, 7, v228
    v_and_b32 v227, 3, v227
    v_lshl_add_u32 v228, v227, 3, v228
    v_lshl_add_u32 v228, v3, 10, v228
    v_and_b32 v227, 16, v1
    v_lshl_add_u32 v228, v227, 1, v228
    v_add_u32 v40, 129584, v228
    s_lshr_b32 s58, s3, 2
    s_and_b32 s59, s3, 3
    s_lshl_b32 s30, s58, 13
    v_add_u32 v41, s30, v40
    v_add_u32 v42, 77584, v228
    s_lshl_b32 s30, s59, 12
    s_sub_u32 s30, s30, s24
    s_add_u32 s30, s30, 85008
    v_add_u32 v204, s30, v28
    v_add_u32 v205, s30, v29
    v_add_u32 v206, s30, v30
    v_add_u32 v207, s30, v31
    s_waitcnt vmcnt(3)
    s_mov_b64 exec, s[40:41]
    global_load_dwordx4 v[128:131], v8, s[74:75]
    global_load_dwordx4 v[136:139], v8, s[72:73]
    global_load_dwordx4 v[144:147], v9, s[56:57]
    global_load_dwordx4 v[148:151], v9, s[56:57] offset:16
    s_mov_b64 exec, -1
    s_mov_b64 exec, s[42:43]
    s_cbranch_execz FK_NH1
    v_mul_u32_u24 v164, 42800, v132
    v_mul_u32_u24 v165, 42800, v133
    v_mul_u32_u24 v166, 42800, v134
    v_mul_u32_u24 v167, 42800, v135
    v_lshrrev_b32 v164, 22, v164
    v_lshrrev_b32 v165, 22, v165
    v_lshrrev_b32 v166, 22, v166
    v_lshrrev_b32 v167, 22, v167
    v_mul_u32_u24 v180, 98, v164
    v_mul_u32_u24 v181, 98, v165
    v_mul_u32_u24 v182, 98, v166
    v_mul_u32_u24 v183, 98, v167
    v_lshlrev_b32 v164, 2, v164
    v_lshlrev_b32 v165, 2, v165
    v_lshlrev_b32 v166, 2, v166
    v_lshlrev_b32 v167, 2, v167
    ds_add_rtn_u32 v172, v164, v7 offset:38560
    ds_add_rtn_u32 v173, v165, v7 offset:38560
    ds_add_rtn_u32 v174, v166, v7 offset:38560
    ds_add_rtn_u32 v175, v167, v7 offset:38560
    v_sub_u32 v132, v132, v180
    v_sub_u32 v133, v133, v181
    v_sub_u32 v134, v134, v182
    v_sub_u32 v135, v135, v183
FK_NH1:
    s_mov_b64 exec, -1
    s_waitcnt lgkmcnt(0)
    s_barrier
    ds_read_b128 v[184:187], v5 offset:38560
    s_cmp_gt_u32 s3, 4
    s_cbranch_scc1 FK_O1_1
    s_waitcnt lgkmcnt(0)
    v_add_u32 v189, v184, v185
    v_add_u32 v190, v189, v186
    v_add_u32 v191, v190, v187
    v_mov_b32 v188, v191
    s_nop 1
    v_add_u32_dpp v188, v188, v188 row_shr:1 row_mask:0xf bank_mask:0xf bound_ctrl:0
    s_nop 1
    v_add_u32_dpp v188, v188, v188 row_shr:2 row_mask:0xf bank_mask:0xf bound_ctrl:0
    s_nop 1
    v_add_u32_dpp v188, v188, v188 row_shr:4 row_mask:0xf bank_mask:0xf bound_ctrl:0
    s_nop 1
    v_add_u32_dpp v188, v188, v188 row_shr:8 row_mask:0xf bank_mask:0xf bound_ctrl:0
    s_nop 1
    v_add_u32_dpp v188, v188, v188 row_bcast:15 row_mask:0xa bank_mask:0xf
    s_nop 1
    v_add_u32_dpp v188, v188, v188 row_bcast:31 row_mask:0xc bank_mask:0xf
    v_sub_u32 v192, v188, v191
    v_add_u32 v192, 2048, v192
    v_add_u32 v193, v192, v184
    v_add_u32 v194, v192, v189
    v_add_u32 v195, v192, v190
    ds_write_b128 v5, v[192:195] offset:40608
    s_mov_b64 exec, s[42:43]
    ds_read_b32 v180, v164 offset:40608
    ds_read_b32 v181, v165 offset:40608
    ds_read_b32 v182, v166 offset:40608
    ds_read_b32 v183, v167 offset:40608
    s_mov_b64 exec, -1
    v_lshl_or_b32 v216, v184, 12, v192
    v_lshl_or_b32 v218, v185, 12, v193
    v_lshl_or_b32 v220, v186, 12, v194
    v_lshl_or_b32 v222, v187, 12, v195
    s_waitcnt vmcnt(4) lgkmcnt(0)
    s_mov_b64 exec, s[42:43]
    v_add_u32 v180, v180, v172
    v_add_u32 v181, v181, v173
    v_add_u32 v182, v182, v174
    v_add_u32 v183, v183, v175
    v_mul_u32_u24 v180, 12, v180
    v_mul_u32_u24 v181, 12, v181
    v_mul_u32_u24 v182, 12, v182
    v_mul_u32_u24 v183, 12, v183
    v_lshl_or_b32 v140, v132, 16, v140
    v_lshl_or_b32 v141, v133, 16, v141
    v_lshl_or_b32 v142, v134, 16, v142
    v_lshl_or_b32 v143, v135, 16, v143
    ds_write2_b32 v180, v152, v153 offset0:0 offset1:1
    ds_write_b32 v180, v140 offset:8
    ds_write2_b32 v181, v154, v155 offset0:0 offset1:1
    ds_write_b32 v181, v141 offset:8
    ds_write2_b32 v182, v156, v157 offset0:0 offset1:1
    ds_write_b32 v182, v142 offset:8
    ds_write2_b32 v183, v158, v159 offset0:0 offset1:1
    ds_write_b32 v183, v143 offset:8
    s_mov_b64 exec, -1
FK_O1_1:
    s_waitcnt vmcnt(3)
    s_mov_b64 exec, s[40:41]
    v_mul_u32_u24 v160, 42800, v128
    v_mul_u32_u24 v161, 42800, v129
    v_mul_u32_u24 v162, 42800, v130
    v_mul_u32_u24 v163, 42800, v131
    v_lshrrev_b32 v160, 22, v160
    v_lshrrev_b32 v161, 22, v161
    v_lshrrev_b32 v162, 22, v162
    v_lshrrev_b32 v163, 22, v163
    v_mul_u32_u24 v176, 98, v160
    v_mul_u32_u24 v177, 98, v161
    v_mul_u32_u24 v178, 98, v162
    v_mul_u32_u24 v179, 98, v163
    v_lshlrev_b32 v160, 2, v160
    v_lshlrev_b32 v161, 2, v161
    v_lshlrev_b32 v162, 2, v162
    v_lshlrev_b32 v163, 2, v163
    ds_add_rtn_u32 v168, v160, v7 offset:37536
    ds_add_rtn_u32 v169, v161, v7 offset:37536
    ds_add_rtn_u32 v170, v162, v7 offset:37536
    ds_add_rtn_u32 v171, v163, v7 offset:37536
    v_sub_u32 v128, v128, v176
    v_sub_u32 v129, v129, v177
    v_sub_u32 v130, v130, v178
    v_sub_u32 v131, v131, v179
    s_mov_b64 exec, -1
    s_waitcnt lgkmcnt(0)
    s_barrier
    ds_read_b128 v[224:227], v23 offset:24576
    ds_read_b128 v[228:231], v23 offset:32768
    ds_read_b128 v[184:187], v5 offset:37536
    v_mov_b32 v37, 0
    global_load_dwordx2 v[38:39], v37, s[88:89] sc0 sc1
    s_mov_b32 s34, 37536
    s_waitcnt lgkmcnt(2)
    s_mov_b32 s31, 24576
    buffer_store_dwordx4 v[224:227], v23, s[32:35], s31 offen sc1
    s_waitcnt lgkmcnt(1)
    s_mov_b32 s31, 32768
    buffer_store_dwordx4 v[228:231], v23, s[32:35], s31 offen sc1
    s_waitcnt lgkmcnt(0)
    v_add_u32 v189, v184, v185
    v_add_u32 v190, v189, v186
    v_add_u32 v191, v190, v187
    v_mov_b32 v188, v191
    s_nop 1
    v_add_u32_dpp v188, v188, v188 row_shr:1 row_mask:0xf bank_mask:0xf bound_ctrl:0
    s_nop 1
    v_add_u32_dpp v188, v188, v188 row_shr:2 row_mask:0xf bank_mask:0xf bound_ctrl:0
    s_nop 1
    v_add_u32_dpp v188, v188, v188 row_shr:4 row_mask:0xf bank_mask:0xf bound_ctrl:0
    s_nop 1
    v_add_u32_dpp v188, v188, v188 row_shr:8 row_mask:0xf bank_mask:0xf bound_ctrl:0
    s_nop 1
    v_add_u32_dpp v188, v188, v188 row_bcast:15 row_mask:0xa bank_mask:0xf
    s_nop 1
    v_add_u32_dpp v188, v188, v188 row_bcast:31 row_mask:0xc bank_mask:0xf
    v_sub_u32 v192, v188, v191
    v_add_u32 v193, v192, v184
    v_add_u32 v194, v192, v189
    v_add_u32 v195, v192, v190
    ds_write_b128 v5, v[192:195] offset:39584
    s_mov_b64 exec, s[40:41]
    ds_read_b32 v176, v160 offset:39584
    ds_read_b32 v177, v161 offset:39584
    ds_read_b32 v178, v162 offset:39584
    ds_read_b32 v179, v163 offset:39584
    s_mov_b64 exec, -1
    v_lshl_or_b32 v208, v184, 12, v192
    v_lshl_or_b32 v210, v185, 12, v193
    v_lshl_or_b32 v212, v186, 12, v194
    v_lshl_or_b32 v214, v187, 12, v195
    s_waitcnt vmcnt(3) lgkmcnt(0)
    s_mov_b64 exec, s[40:41]
    v_add_u32 v176, v176, v168
    v_add_u32 v177, v177, v169
    v_add_u32 v178, v178, v170
    v_add_u32 v179, v179, v171
    v_mul_u32_u24 v176, 12, v176
    v_mul_u32_u24 v177, 12, v177
    v_mul_u32_u24 v178, 12, v178
    v_mul_u32_u24 v179, 12, v179
    v_lshl_or_b32 v136, v128, 16, v136
    v_lshl_or_b32 v137, v129, 16, v137
    v_lshl_or_b32 v138, v130, 16, v138
    v_lshl_or_b32 v139, v131, 16, v139
    ds_write2_b32 v176, v144, v145 offset0:0 offset1:1
    ds_write_b32 v176, v136 offset:8
    ds_write2_b32 v177, v146, v147 offset0:0 offset1:1
    ds_write_b32 v177, v137 offset:8
    ds_write2_b32 v178, v148, v149 offset0:0 offset1:1
    ds_write_b32 v178, v138 offset:8
    ds_write2_b32 v179, v150, v151 offset0:0 offset1:1
    ds_write_b32 v179, v139 offset:8
    s_mov_b64 exec, -1
    s_waitcnt lgkmcnt(0)
    s_barrier
    ds_read_b128 v[240:243], v23 offset:0
    ds_read_b128 v[244:247], v23 offset:8192
    ds_read_b128 v[248:251], v23 offset:16384
    s_waitcnt lgkmcnt(2)
    s_mov_b32 s31, 0
    buffer_store_dwordx4 v[240:243], v23, s[32:35], s31 offen sc1
    s_waitcnt lgkmcnt(1)
    s_mov_b32 s31, 8192
    buffer_store_dwordx4 v[244:247], v23, s[32:35], s31 offen sc1
    s_waitcnt lgkmcnt(0)
    s_mov_b32 s31, 16384
    buffer_store_dwordx4 v[248:251], v23, s[32:35], s31 offen sc1
    s_mov_b32 s12, s90
    s_and_b32 s13, s91, 0xffff
    s_mov_b32 s14, 67108864
    s_mov_b32 s15, 0x20000
    s_waitcnt vmcnt(5)
    s_mov_b32 s31, 400000
FK_NONCE:
    v_readfirstlane_b32 s92, v38
    v_readfirstlane_b32 s93, v39
    s_or_b32 s30, s92, s93
    s_cbranch_scc1 FK_NONCED
    s_sub_u32 s31, s31, 1
    s_cbranch_scc1 FK_NONCED
    s_sleep 1
    global_load_dwordx2 v[38:39], v37, s[88:89] sc0 sc1
    s_waitcnt vmcnt(0)
    s_branch FK_NONCE
FK_NONCED:
    s_lshr_b64 s[94:95], s[92:93], 8
    s_lshl_b32 s92, s92, 24
    s_mov_b32 s93, s94
    s_cmp_lg_u32 s3, 0
    s_cbranch_scc1 FK_NOPW
    v_or_b32 v208, s92, v208
    v_mov_b32 v209, s93
    v_or_b32 v210, s92, v210
    v_mov_b32 v211, s93
    v_or_b32 v212, s92, v212
    v_mov_b32 v213, s93
    v_or_b32 v214, s92, v214
    v_mov_b32 v215, s93
    v_or_b32 v216, s92, v216
    v_mov_b32 v217, s93
    v_or_b32 v218, s92, v218
    v_mov_b32 v219, s93
    v_or_b32 v220, s92, v220
    v_mov_b32 v221, s93
    v_or_b32 v222, s92, v222
    v_mov_b32 v223, s93
    v_lshlrev_b32 v6, 5, v1
    s_lshl_b32 s29, s2, 12
    s_add_u32 s29, s29, 65536
FK_NOPW:
    s_waitcnt vmcnt(0)
    s_barrier
    s_cmp_lg_u32 s3, 0
    s_cbranch_scc1 FK_NOPUB
    buffer_store_dwordx4 v[208:211], v6, s[12:15], s29 offen sc1
    buffer_store_dwordx4 v[212:215], v6, s[12:15], s29 offen offset:16 sc1
    buffer_store_dwordx4 v[216:219], v6, s[12:15], s29 offen offset:2048 sc1
    buffer_store_dwordx4 v[220:223], v6, s[12:15], s29 offen offset:2064 sc1
    s_lshl_b32 s29, s2, 2
    s_add_u32 s29, s29, 0
    s_mov_b64 exec, 1
    buffer_store_dword v209, v37, s[12:15], s29 offen sc1
    s_mov_b64 exec, -1
FK_NOPUB:
    s_lshl_b32 s26, s70, 3
    s_add_u32 s26, s26, 65536
    s_lshl_b32 s30, s3, 10
    s_add_u32 m0, s30, 137776
    global_load_dwordx4 v[200:203], v23, s[78:79]
    global_load_lds_dwordx4 v23, s[84:85]
    s_add_u32 m0, s30, 145968
    s_lshl_b32 s31, s3, 11
    global_load_lds_dwordx4 v23, s[76:77]
    s_add_u32 m0, s30, 154160
    s_nop 0
    global_load_lds_dwordx4 v23, s[82:83]
    s_add_u32 m0, s31, 85008
    s_nop 0
    buffer_load_dwordx4 v20, s[4:7], 0 offen lds
    s_add_u32 m0, s31, 86032
    s_nop 0
    buffer_load_dwordx4 v21, s[4:7], 0 offen lds
    s_mov_b32 exec_hi, 0
    global_load_dwordx4 v[12:15], v5, s[80:81]
    s_mov_b32 exec_hi, -1
    s_waitcnt vmcnt(0)
    v_lshlrev_b32 v184, 16, v200
    v_and_b32 v185, 0xffff0000, v200
    v_lshlrev_b32 v186, 16, v201
    v_and_b32 v187, 0xffff0000, v201
    v_lshlrev_b32 v188, 16, v202
    v_and_b32 v189, 0xffff0000, v202
    v_lshlrev_b32 v190, 16, v203
    v_and_b32 v191, 0xffff0000, v203
    v_mul_f32 v184, 3216550459, v184
    v_mul_f32 v185, 3216550459, v185
    v_mul_f32 v186, 3216550459, v186
    v_mul_f32 v187, 3216550459, v187
    v_mul_f32 v188, 3216550459, v188
    v_mul_f32 v189, 3216550459, v189
    v_mul_f32 v190, 3216550459, v190
    v_mul_f32 v191, 3216550459, v191
    v_cvt_pk_bf16_f32 v200, v184, v185
    v_cvt_pk_bf16_f32 v201, v186, v187
    v_cvt_pk_bf16_f32 v202, v188, v189
    v_cvt_pk_bf16_f32 v203, v190, v191
    v_add_u32 v10, 129584, v23
    ds_write_b128 v10, v[200:203]
    s_cmp_lg_u32 s3, 7
    s_cbranch_scc1 FK_N7B
    v_lshlrev_b32 v184, 16, v12
    v_and_b32 v185, 0xffff0000, v12
    v_lshlrev_b32 v186, 16, v13
    v_and_b32 v187, 0xffff0000, v13
    v_lshlrev_b32 v188, 16, v14
    v_and_b32 v189, 0xffff0000, v14
    v_lshlrev_b32 v190, 16, v15
    v_and_b32 v191, 0xffff0000, v15
    v_mul_f32 v184, 3216550459, v184
    v_mul_f32 v185, 3216550459, v185
    v_mul_f32 v186, 3216550459, v186
    v_mul_f32 v187, 3216550459, v187
    v_mul_f32 v188, 3216550459, v188
    v_mul_f32 v189, 3216550459, v189
    v_mul_f32 v190, 3216550459, v190
    v_mul_f32 v191, 3216550459, v191
    v_cvt_pk_bf16_f32 v12, v184, v185
    v_cvt_pk_bf16_f32 v13, v186, v187
    v_cvt_pk_bf16_f32 v14, v188, v189
    v_cvt_pk_bf16_f32 v15, v190, v191
    v_add_u32 v10, 77584, v5
    s_mov_b32 exec_hi, 0
    ds_write_b128 v10, v[12:15]
    s_mov_b32 exec_hi, -1
FK_N7B:
    s_waitcnt lgkmcnt(0)
    s_barrier
    ds_read_b128 v[192:195], v204
    ds_read_b128 v[196:199], v205
    ds_read_b128 v[200:203], v206
    ds_read_b128 v[204:207], v207
    ds_read_b64_tr_b16 v[148:149], v41 offset:16384
    ds_read_b64_tr_b16 v[150:151], v41 offset:16896
    ds_read_b64_tr_b16 v[152:153], v41 offset:18432
    ds_read_b64_tr_b16 v[154:155], v41 offset:18944
    ds_read_b64_tr_b16 v[156:157], v41 offset:20480
    ds_read_b64_tr_b16 v[158:159], v41 offset:20992
    ds_read_b64_tr_b16 v[160:161], v41 offset:22528
    ds_read_b64_tr_b16 v[162:163], v41 offset:23040
    ds_read_b64_tr_b16 v[164:165], v41 offset:16448
    ds_read_b64_tr_b16 v[166:167], v41 offset:16960
    ds_read_b64_tr_b16 v[168:169], v41 offset:18496
    ds_read_b64_tr_b16 v[170:171], v41 offset:19008
    ds_read_b64_tr_b16 v[172:173], v41 offset:20544
    ds_read_b64_tr_b16 v[174:175], v41 offset:21056
    ds_read_b64_tr_b16 v[176:177], v41 offset:22592
    ds_read_b64_tr_b16 v[178:179], v41 offset:23104
    s_waitcnt lgkmcnt(8)
    v_mfma_f32_32x32x16_bf16 v[224:239], v[192:195], v[148:151], 0
    v_mfma_f32_32x32x16_bf16 v[224:239], v[196:199], v[152:155], v[224:239]
    v_mfma_f32_32x32x16_bf16 v[224:239], v[200:203], v[156:159], v[224:239]
    v_mfma_f32_32x32x16_bf16 v[224:239], v[204:207], v[160:163], v[224:239]
    s_waitcnt lgkmcnt(0)
    v_mfma_f32_32x32x16_bf16 v[240:255], v[192:195], v[164:167], 0
    v_mfma_f32_32x32x16_bf16 v[240:255], v[196:199], v[168:171], v[240:255]
    v_mfma_f32_32x32x16_bf16 v[240:255], v[200:203], v[172:175], v[240:255]
    v_mfma_f32_32x32x16_bf16 v[240:255], v[204:207], v[176:179], v[240:255]
    s_lshl_b32 s27, s3, 7
    s_add_u32 s27, s27, 0
    buffer_load_dword v38, v36, s[12:15], s27 offen sc1
    ds_read_b64_tr_b16 v[64:65], v40 offset:0
    ds_read_b64_tr_b16 v[66:67], v40 offset:512
    ds_read_b64_tr_b16 v[68:69], v40 offset:64
    ds_read_b64_tr_b16 v[70:71], v40 offset:576
    ds_read_b64_tr_b16 v[72:73], v40 offset:2048
    ds_read_b64_tr_b16 v[74:75], v40 offset:2560
    ds_read_b64_tr_b16 v[76:77], v40 offset:2112
    ds_read_b64_tr_b16 v[78:79], v40 offset:2624
    ds_read_b64_tr_b16 v[80:81], v40 offset:4096
    ds_read_b64_tr_b16 v[82:83], v40 offset:4608
    ds_read_b64_tr_b16 v[84:85], v40 offset:4160
    ds_read_b64_tr_b16 v[86:87], v40 offset:4672
    ds_read_b64_tr_b16 v[88:89], v40 offset:6144
    ds_read_b64_tr_b16 v[90:91], v40 offset:6656
    ds_read_b64_tr_b16 v[92:93], v40 offset:6208
    ds_read_b64_tr_b16 v[94:95], v40 offset:6720
    ds_read_b64_tr_b16 v[96:97], v40 offset:8192
    ds_read_b64_tr_b16 v[98:99], v40 offset:8704
    ds_read_b64_tr_b16 v[100:101], v40 offset:8256
    ds_read_b64_tr_b16 v[102:103], v40 offset:8768
    ds_read_b64_tr_b16 v[104:105], v40 offset:10240
    ds_read_b64_tr_b16 v[106:107], v40 offset:10752
    ds_read_b64_tr_b16 v[108:109], v40 offset:10304
    ds_read_b64_tr_b16 v[110:111], v40 offset:10816
    ds_read_b64_tr_b16 v[112:113], v40 offset:12288
    ds_read_b64_tr_b16 v[114:115], v40 offset:12800
    ds_read_b64_tr_b16 v[116:117], v40 offset:12352
    ds_read_b64_tr_b16 v[118:119], v40 offset:12864
    ds_read_b64_tr_b16 v[120:121], v40 offset:14336
    ds_read_b64_tr_b16 v[122:123], v40 offset:14848
    ds_read_b64_tr_b16 v[124:125], v40 offset:14400
    ds_read_b64_tr_b16 v[126:127], v40 offset:14912
    ds_read_b64_tr_b16 v[46:47], v42
    ds_read_b64_tr_b16 v[54:55], v42 offset:64
    s_cmp_lg_u32 s58, 0
    s_cbranch_scc1 FK_XU
    v_mul_u32_u24 v7, 2560, v3
    v_add_u32 v7, v36, v7
    s_mul_i32 s31, s59, 20480
    s_add_u32 s31, s31, 512
    v_add_u32 v7, s31, v7
    v_mul_f32 v224, 3216550459, v224
    v_mul_f32 v225, 3216550459, v225
    v_mul_f32 v226, 3216550459, v226
    v_mul_f32 v227, 3216550459, v227
    v_mul_f32 v228, 3216550459, v228
    v_mul_f32 v229, 3216550459, v229
    v_mul_f32 v230, 3216550459, v230
    v_mul_f32 v231, 3216550459, v231
    v_mul_f32 v232, 3216550459, v232
    v_mul_f32 v233, 3216550459, v233
    v_mul_f32 v234, 3216550459, v234
    v_mul_f32 v235, 3216550459, v235
    v_mul_f32 v236, 3216550459, v236
    v_mul_f32 v237, 3216550459, v237
    v_mul_f32 v238, 3216550459, v238
    v_mul_f32 v239, 3216550459, v239
    v_mul_f32 v240, 3216550459, v240
    v_mul_f32 v241, 3216550459, v241
    v_mul_f32 v242, 3216550459, v242
    v_mul_f32 v243, 3216550459, v243
    v_mul_f32 v244, 3216550459, v244
    v_mul_f32 v245, 3216550459, v245
    v_mul_f32 v246, 3216550459, v246
    v_mul_f32 v247, 3216550459, v247
    v_mul_f32 v248, 3216550459, v248
    v_mul_f32 v249, 3216550459, v249
    v_mul_f32 v250, 3216550459, v250
    v_mul_f32 v251, 3216550459, v251
    v_mul_f32 v252, 3216550459, v252
    v_mul_f32 v253, 3216550459, v253
    v_mul_f32 v254, 3216550459, v254
    v_mul_f32 v255, 3216550459, v255
    v_cvt_pk_bf16_f32 v224, v224, v240
    v_cvt_pk_bf16_f32 v225, v225, v241
    v_cvt_pk_bf16_f32 v226, v226, v242
    v_cvt_pk_bf16_f32 v227, v227, v243
    v_cvt_pk_bf16_f32 v228, v228, v244
    v_cvt_pk_bf16_f32 v229, v229, v245
    v_cvt_pk_bf16_f32 v230, v230, v246
    v_cvt_pk_bf16_f32 v231, v231, v247
    v_cvt_pk_bf16_f32 v232, v232, v248
    v_cvt_pk_bf16_f32 v233, v233, v249
    v_cvt_pk_bf16_f32 v234, v234, v250
    v_cvt_pk_bf16_f32 v235, v235, v251
    v_cvt_pk_bf16_f32 v236, v236, v252
    v_cvt_pk_bf16_f32 v237, v237, v253
    v_cvt_pk_bf16_f32 v238, v238, v254
    v_cvt_pk_bf16_f32 v239, v239, v255
    s_cmp_eq_u32 s59, 3
    s_cbranch_scc1 FK_XA3
    ds_write_b32 v7, v224 offset:0
    ds_write_b32 v7, v225 offset:640
    ds_write_b32 v7, v226 offset:1280
    ds_write_b32 v7, v227 offset:1920
    ds_write_b32 v7, v228 offset:5120
    ds_write_b32 v7, v229 offset:5760
    ds_write_b32 v7, v230 offset:6400
    ds_write_b32 v7, v231 offset:7040
    ds_write_b32 v7, v232 offset:10240
    ds_write_b32 v7, v233 offset:10880
    ds_write_b32 v7, v234 offset:11520
    ds_write_b32 v7, v235 offset:12160
    ds_write_b32 v7, v236 offset:15360
    ds_write_b32 v7, v237 offset:16000
    ds_write_b32 v7, v238 offset:16640
    ds_write_b32 v7, v239 offset:17280
    s_branch FK_XA4
FK_XA3:
    s_mov_b32 exec_hi, 0
    ds_write_b32 v7, v224 offset:0
    ds_write_b32 v7, v225 offset:640
    s_mov_b64 exec, -1
    s_branch FK_XA4
FK_XU:
    v_lshl_add_u32 v8, v3, 9, v36
    s_lshl_b32 s31, s2, 14
    s_lshl_b32 s30, s59, 12
    s_add_u32 s31, s31, s30
    s_add_u32 s31, s31, 12582912
    v_cvt_pk_bf16_f32 v208, v224, v240
    v_cvt_pk_bf16_f32 v209, v225, v241
    v_cvt_pk_bf16_f32 v210, v226, v242
    v_cvt_pk_bf16_f32 v211, v227, v243
    v_cvt_pk_bf16_f32 v212, v228, v244
    v_cvt_pk_bf16_f32 v213, v229, v245
    v_cvt_pk_bf16_f32 v214, v230, v246
    v_cvt_pk_bf16_f32 v215, v231, v247
    v_cvt_pk_bf16_f32 v216, v232, v248
    v_cvt_pk_bf16_f32 v217, v233, v249
    v_cvt_pk_bf16_f32 v218, v234, v250
    v_cvt_pk_bf16_f32 v219, v235, v251
    v_cvt_pk_bf16_f32 v220, v236, v252
    v_cvt_pk_bf16_f32 v221, v237, v253
    v_cvt_pk_bf16_f32 v222, v238, v254
    v_cvt_pk_bf16_f32 v223, v239, v255
    v_mov_b32 v193, v8
    s_mov_b32 s73, s31
FK_XA4:
    s_waitcnt lgkmcnt(0)
    s_mov_b32 exec_lo, 0
    v_mov_b32 v46, 2130706432
    v_mov_b32 v47, 0
    v_mov_b32 v54, 2130706432
    v_mov_b32 v55, 0
    s_mov_b32 exec_lo, -1
FK_XAD:
    s_mov_b32 s74, 0x05040100
    s_mov_b32 s75, 0x07060302
    s_lshl_b32 s29, s3, 8
    s_add_u32 s29, s29, 75024
    s_lshl_b32 s30, s3, 6
    s_add_u32 s30, s30, 74512
    s_mov_b32 s31, 400000
    s_mov_b64 s[64:65], -1
FK_RPOLL:
    s_waitcnt vmcnt(0)
    v_cmp_ne_u32 vcc, s93, v38
    s_cbranch_vccz FK_RGOT
    s_sub_u32 s31, s31, 1
    s_cbranch_scc1 FK_RGOT
    s_sleep 8
    buffer_load_dword v38, v36, s[12:15], s27 offen sc1
    s_branch FK_RPOLL
FK_RGOT:
    s_mov_b32 s31, 400000
    buffer_load_dwordx2 v[38:39], v16, s[12:15], s26 offen sc1
FK_POLL:
    s_waitcnt vmcnt(0)
    v_and_b32 v8, 0xff000000, v38
    v_cmp_eq_u32 s[34:35], s93, v39
    v_cmp_eq_u32 s[36:37], s92, v8
    s_nand_b64 s[34:35], s[34:35], s[36:37]
    s_cbranch_scc0 FK_GOT
    s_sub_u32 s31, s31, 1
    s_cbranch_scc1 FK_GOT
    s_sleep 8
    s_mov_b64 exec, s[34:35]
    buffer_load_dwordx2 v[38:39], v16, s[12:15], s26 offen sc1
    s_mov_b64 exec, -1
    s_branch FK_POLL
FK_GOT:
    s_mov_b64 exec, -1
    v_bfe_u32 v8, v38, 12, 12
    v_and_b32 v9, 0xfff, v38
    v_mov_b32 v230, v8
    v_min_u32 v8, s17, v8
    v_subrev_u32 v8, s16, v8
    v_max_i32 v8, 0, v8
    v_mov_b32 v10, v8
    v_add_u32 v9, s16, v9
    s_nop 1
    v_add_u32_dpp v10, v10, v10 row_shr:1 row_mask:0xf bank_mask:0xf bound_ctrl:0
    s_nop 1
    v_add_u32_dpp v10, v10, v10 row_shr:2 row_mask:0xf bank_mask:0xf bound_ctrl:0
    s_nop 1
    v_add_u32_dpp v10, v10, v10 row_shr:4 row_mask:0xf bank_mask:0xf bound_ctrl:0
    s_nop 1
    v_add_u32_dpp v10, v10, v10 row_shr:8 row_mask:0xf bank_mask:0xf bound_ctrl:0
    s_nop 1
    v_add_u32_dpp v10, v10, v10 row_bcast:15 row_mask:0xa bank_mask:0xf
    s_nop 1
    v_add_u32_dpp v10, v10, v10 row_bcast:31 row_mask:0xc bank_mask:0xf
    v_cmp_lt_u32 s[34:35], 0, v8
    v_sub_u32 v11, v10, v8
    v_readlane_b32 s20, v10, 63
    v_sub_u32 v9, v9, v11
    v_mul_i32_i24 v9, 12, v9
    v_add_u32 v9, v9, v63
    v_mbcnt_lo_u32_b32 v12, s34, 0
    v_mbcnt_hi_u32_b32 v12, s35, v12
    v_lshl_add_u32 v12, v12, 2, s29
    v_add_u32 v13, -1, v11
    v_lshrrev_b32 v14, 5, v13
    v_min_u32 v14, 15, v14
    v_lshl_add_u32 v14, v14, 2, s30
    v_lshlrev_b32 v13, v13, 1
    v_cmp_lt_u32 s[36:37], 0, v11
    v_mov_b32 v229, s30
    s_mov_b64 exec, s[34:35]
    ds_write_b32 v12, v9
    s_and_b64 exec, s[34:35], s[36:37]
    ds_or_b32 v14, v13
    s_mov_b64 exec, -1
    ds_read_b128 v[232:235], v229
    ds_read_b128 v[236:239], v229 offset:16
    ds_read_b128 v[240:243], v229 offset:32
    ds_read_b128 v[244:247], v229 offset:48
    s_lshr_b32 s31, s29, 2
    v_mov_b32 v15, s31
    s_sub_i32 s31, s20, 0
    v_cmp_gt_i32 s[40:41], s31, v1
    s_sub_i32 s31, s20, 64
    v_cmp_gt_i32 s[42:43], s31, v1
    s_sub_i32 s31, s20, 128
    v_cmp_gt_i32 s[44:45], s31, v1
    s_sub_i32 s31, s20, 192
    v_cmp_gt_i32 s[46:47], s31, v1
    s_sub_i32 s31, s20, 256
    v_cmp_gt_i32 s[48:49], s31, v1
    s_sub_i32 s31, s20, 320
    v_cmp_gt_i32 s[50:51], s31, v1
    s_sub_i32 s31, s20, 384
    v_cmp_gt_i32 s[52:53], s31, v1
    s_sub_i32 s31, s20, 448
    v_cmp_gt_i32 s[54:55], s31, v1
    s_waitcnt lgkmcnt(3)
    v_mbcnt_lo_u32_b32 v160, v232, v15
    v_mbcnt_hi_u32_b32 v160, v233, v160
    v_bcnt_u32_b32 v15, v232, v15
    v_lshlrev_b32 v160, 2, v160
    v_bcnt_u32_b32 v15, v233, v15
    ds_read_b32 v160, v160
    v_mbcnt_lo_u32_b32 v161, v234, v15
    v_mbcnt_hi_u32_b32 v161, v235, v161
    v_bcnt_u32_b32 v15, v234, v15
    v_lshlrev_b32 v161, 2, v161
    v_bcnt_u32_b32 v15, v235, v15
    ds_read_b32 v161, v161
    s_waitcnt lgkmcnt(4)
    v_mbcnt_lo_u32_b32 v162, v236, v15
    v_mbcnt_hi_u32_b32 v162, v237, v162
    v_bcnt_u32_b32 v15, v236, v15
    v_lshlrev_b32 v162, 2, v162
    v_bcnt_u32_b32 v15, v237, v15
    ds_read_b32 v162, v162
    v_mbcnt_lo_u32_b32 v163, v238, v15
    v_mbcnt_hi_u32_b32 v163, v239, v163
    v_bcnt_u32_b32 v15, v238, v15
    v_lshlrev_b32 v163, 2, v163
    v_bcnt_u32_b32 v15, v239, v15
    ds_read_b32 v163, v163
    s_waitcnt lgkmcnt(5)
    v_mbcnt_lo_u32_b32 v164, v240, v15
    v_mbcnt_hi_u32_b32 v164, v241, v164
    v_bcnt_u32_b32 v15, v240, v15
    v_lshlrev_b32 v164, 2, v164
    v_bcnt_u32_b32 v15, v241, v15
    ds_read_b32 v164, v164
    v_mbcnt_lo_u32_b32 v165, v242, v15
    v_mbcnt_hi_u32_b32 v165, v243, v165
    v_bcnt_u32_b32 v15, v242, v15
    v_lshlrev_b32 v165, 2, v165
    v_bcnt_u32_b32 v15, v243, v15
    ds_read_b32 v165, v165
    s_cmp_gt_u32 s20, 384
    s_cbranch_scc1 FK_P7
    s_waitcnt lgkmcnt(5)
    v_add_u32 v160, v160, v61
    s_mov_b64 exec, s[40:41]
    buffer_load_dwordx3 v[128:130], v160, s[12:15], 0 offen offset:0 sc1
    s_waitcnt lgkmcnt(4)
    v_add_u32 v161, v161, v61
    s_mov_b64 exec, s[42:43]
    buffer_load_dwordx3 v[132:134], v161, s[12:15], 0 offen offset:768 sc1
    s_waitcnt lgkmcnt(3)
    v_add_u32 v162, v162, v61
    s_mov_b64 exec, s[44:45]
    buffer_load_dwordx3 v[136:138], v162, s[12:15], 0 offen offset:1536 sc1
    s_waitcnt lgkmcnt(2)
    v_add_u32 v163, v163, v61
    s_mov_b64 exec, s[46:47]
    buffer_load_dwordx3 v[140:142], v163, s[12:15], 0 offen offset:2304 sc1
    s_waitcnt lgkmcnt(1)
    v_add_u32 v164, v164, v61
    s_mov_b64 exec, s[48:49]
    buffer_load_dwordx3 v[144:146], v164, s[12:15], 0 offen offset:3072 sc1
    s_waitcnt lgkmcnt(0)
    v_add_u32 v165, v165, v61
    s_mov_b64 exec, s[50:51]
    buffer_load_dwordx3 v[148:150], v165, s[12:15], 0 offen offset:3840 sc1
    s_mov_b64 exec, -1
    s_cmp_gt_u32 s20, 512
    s_cselect_b32 s71, 0x10000, 0
    s_or_b32 s31, s71, s18
    s_cbranch_scc0 FK_NOMAX6
    v_or_b32 v230, s71, v230
    ds_max_u32 v17, v230
FK_NOMAX6:
    v_lshl_add_u32 v8, v2, 2, s29
    v_mov_b32 v9, 0
    ds_write_b32 v8, v9
    s_mov_b32 s62, s29
    v_mov_b32 v231, 1
    v_add_u32 v241, 72960, v62
    s_mov_b32 s31, 72960
    s_mov_b32 m0, s24
    s_waitcnt vmcnt(5)
    s_mov_b64 exec, s[40:41]
    v_bfe_u32 v160, v130, 16, 7
    v_lshl_add_u32 v160, v160, 2, s31
    ds_add_rtn_u32 v131, v160, v231
    s_waitcnt vmcnt(4)
    s_mov_b64 exec, s[42:43]
    v_bfe_u32 v161, v134, 16, 7
    v_lshl_add_u32 v161, v161, 2, s31
    ds_add_rtn_u32 v135, v161, v231
    s_waitcnt vmcnt(3)
    s_mov_b64 exec, s[44:45]
    v_bfe_u32 v162, v138, 16, 7
    v_lshl_add_u32 v162, v162, 2, s31
    ds_add_rtn_u32 v139, v162, v231
    s_waitcnt vmcnt(2)
    s_mov_b64 exec, s[46:47]
    v_bfe_u32 v163, v142, 16, 7
    v_lshl_add_u32 v163, v163, 2, s31
    ds_add_rtn_u32 v143, v163, v231
    s_waitcnt vmcnt(1)
    s_mov_b64 exec, s[48:49]
    v_bfe_u32 v164, v146, 16, 7
    v_lshl_add_u32 v164, v164, 2, s31
    ds_add_rtn_u32 v147, v164, v231
    s_waitcnt vmcnt(0)
    s_mov_b64 exec, s[50:51]
    v_bfe_u32 v165, v150, 16, 7
    v_lshl_add_u32 v165, v165, 2, s31
    ds_add_rtn_u32 v151, v165, v231
    s_branch FK_HD
FK_P7:
    s_waitcnt lgkmcnt(6)
    v_mbcnt_lo_u32_b32 v166, v244, v15
    v_mbcnt_hi_u32_b32 v166, v245, v166
    v_bcnt_u32_b32 v15, v244, v15
    v_lshlrev_b32 v166, 2, v166
    v_bcnt_u32_b32 v15, v245, v15
    ds_read_b32 v166, v166
    s_cmp_gt_u32 s20, 448
    s_cbranch_scc1 FK_P8
    s_waitcnt lgkmcnt(6)
    v_add_u32 v160, v160, v61
    s_mov_b64 exec, s[40:41]
    buffer_load_dwordx3 v[128:130], v160, s[12:15], 0 offen offset:0 sc1
    s_waitcnt lgkmcnt(5)
    v_add_u32 v161, v161, v61
    s_mov_b64 exec, s[42:43]
    buffer_load_dwordx3 v[132:134], v161, s[12:15], 0 offen offset:768 sc1
    s_waitcnt lgkmcnt(4)
    v_add_u32 v162, v162, v61
    s_mov_b64 exec, s[44:45]
    buffer_load_dwordx3 v[136:138], v162, s[12:15], 0 offen offset:1536 sc1
    s_waitcnt lgkmcnt(3)
    v_add_u32 v163, v163, v61
    s_mov_b64 exec, s[46:47]
    buffer_load_dwordx3 v[140:142], v163, s[12:15], 0 offen offset:2304 sc1
    s_waitcnt lgkmcnt(2)
    v_add_u32 v164, v164, v61
    s_mov_b64 exec, s[48:49]
    buffer_load_dwordx3 v[144:146], v164, s[12:15], 0 offen offset:3072 sc1
    s_waitcnt lgkmcnt(1)
    v_add_u32 v165, v165, v61
    s_mov_b64 exec, s[50:51]
    buffer_load_dwordx3 v[148:150], v165, s[12:15], 0 offen offset:3840 sc1
    s_waitcnt lgkmcnt(0)
    v_add_u32 v166, v166, v61
    s_mov_b32 s31, 4608
    s_mov_b64 exec, s[52:53]
    buffer_load_dwordx3 v[152:154], v166, s[12:15], s31 offen sc1
    s_mov_b64 exec, -1
    s_cmp_gt_u32 s20, 512
    s_cselect_b32 s71, 0x10000, 0
    s_or_b32 s31, s71, s18
    s_cbranch_scc0 FK_NOMAX7
    v_or_b32 v230, s71, v230
    ds_max_u32 v17, v230
FK_NOMAX7:
    v_lshl_add_u32 v8, v2, 2, s29
    v_mov_b32 v9, 0
    ds_write_b32 v8, v9
    s_mov_b32 s62, s29
    v_mov_b32 v231, 1
    v_add_u32 v241, 72960, v62
    s_mov_b32 s31, 72960
    s_mov_b32 m0, s24
    s_waitcnt vmcnt(6)
    s_mov_b64 exec, s[40:41]
    v_bfe_u32 v160, v130, 16, 7
    v_lshl_add_u32 v160, v160, 2, s31
    ds_add_rtn_u32 v131, v160, v231
    s_waitcnt vmcnt(5)
    s_mov_b64 exec, s[42:43]
    v_bfe_u32 v161, v134, 16, 7
    v_lshl_add_u32 v161, v161, 2, s31
    ds_add_rtn_u32 v135, v161, v231
    s_waitcnt vmcnt(4)
    s_mov_b64 exec, s[44:45]
    v_bfe_u32 v162, v138, 16, 7
    v_lshl_add_u32 v162, v162, 2, s31
    ds_add_rtn_u32 v139, v162, v231
    s_waitcnt vmcnt(3)
    s_mov_b64 exec, s[46:47]
    v_bfe_u32 v163, v142, 16, 7
    v_lshl_add_u32 v163, v163, 2, s31
    ds_add_rtn_u32 v143, v163, v231
    s_waitcnt vmcnt(2)
    s_mov_b64 exec, s[48:49]
    v_bfe_u32 v164, v146, 16, 7
    v_lshl_add_u32 v164, v164, 2, s31
    ds_add_rtn_u32 v147, v164, v231
    s_waitcnt vmcnt(1)
    s_mov_b64 exec, s[50:51]
    v_bfe_u32 v165, v150, 16, 7
    v_lshl_add_u32 v165, v165, 2, s31
    ds_add_rtn_u32 v151, v165, v231
    s_waitcnt vmcnt(0)
    s_mov_b64 exec, s[52:53]
    v_bfe_u32 v166, v154, 16, 7
    v_lshl_add_u32 v166, v166, 2, s31
    ds_add_rtn_u32 v155, v166, v231
    s_branch FK_HD
FK_P8:
    v_mbcnt_lo_u32_b32 v167, v246, v15
    v_mbcnt_hi_u32_b32 v167, v247, v167
    v_lshlrev_b32 v167, 2, v167
    ds_read_b32 v167, v167
    s_waitcnt lgkmcnt(7)
    v_add_u32 v160, v160, v61
    s_mov_b64 exec, s[40:41]
    buffer_load_dwordx3 v[128:130], v160, s[12:15], 0 offen offset:0 sc1
    s_waitcnt lgkmcnt(6)
    v_add_u32 v161, v161, v61
    s_mov_b64 exec, s[42:43]
    buffer_load_dwordx3 v[132:134], v161, s[12:15], 0 offen offset:768 sc1
    s_waitcnt lgkmcnt(5)
    v_add_u32 v162, v162, v61
    s_mov_b64 exec, s[44:45]
    buffer_load_dwordx3 v[136:138], v162, s[12:15], 0 offen offset:1536 sc1
    s_waitcnt lgkmcnt(4)
    v_add_u32 v163, v163, v61
    s_mov_b64 exec, s[46:47]
    buffer_load_dwordx3 v[140:142], v163, s[12:15], 0 offen offset:2304 sc1
    s_waitcnt lgkmcnt(3)
    v_add_u32 v164, v164, v61
    s_mov_b64 exec, s[48:49]
    buffer_load_dwordx3 v[144:146], v164, s[12:15], 0 offen offset:3072 sc1
    s_waitcnt lgkmcnt(2)
    v_add_u32 v165, v165, v61
    s_mov_b64 exec, s[50:51]
    buffer_load_dwordx3 v[148:150], v165, s[12:15], 0 offen offset:3840 sc1
    s_waitcnt lgkmcnt(1)
    v_add_u32 v166, v166, v61
    s_mov_b32 s31, 4608
    s_mov_b64 exec, s[52:53]
    buffer_load_dwordx3 v[152:154], v166, s[12:15], s31 offen sc1
    s_waitcnt lgkmcnt(0)
    v_add_u32 v167, v167, v61
    s_mov_b32 s31, 5376
    s_mov_b64 exec, s[54:55]
    buffer_load_dwordx3 v[156:158], v167, s[12:15], s31 offen sc1
    s_mov_b64 exec, -1
    s_cmp_gt_u32 s20, 512
    s_cselect_b32 s71, 0x10000, 0
    s_or_b32 s31, s71, s18
    s_cbranch_scc0 FK_NOMAX8
    v_or_b32 v230, s71, v230
    ds_max_u32 v17, v230
FK_NOMAX8:
    v_lshl_add_u32 v8, v2, 2, s29
    v_mov_b32 v9, 0
    ds_write_b32 v8, v9
    s_mov_b32 s62, s29
    v_mov_b32 v231, 1
    v_add_u32 v241, 72960, v62
    s_mov_b32 s31, 72960
    s_mov_b32 m0, s24
    s_waitcnt vmcnt(7)
    s_mov_b64 exec, s[40:41]
    v_bfe_u32 v160, v130, 16, 7
    v_lshl_add_u32 v160, v160, 2, s31
    ds_add_rtn_u32 v131, v160, v231
    s_waitcnt vmcnt(6)
    s_mov_b64 exec, s[42:43]
    v_bfe_u32 v161, v134, 16, 7
    v_lshl_add_u32 v161, v161, 2, s31
    ds_add_rtn_u32 v135, v161, v231
    s_waitcnt vmcnt(5)
    s_mov_b64 exec, s[44:45]
    v_bfe_u32 v162, v138, 16, 7
    v_lshl_add_u32 v162, v162, 2, s31
    ds_add_rtn_u32 v139, v162, v231
    s_waitcnt vmcnt(4)
    s_mov_b64 exec, s[46:47]
    v_bfe_u32 v163, v142, 16, 7
    v_lshl_add_u32 v163, v163, 2, s31
    ds_add_rtn_u32 v143, v163, v231
    s_waitcnt vmcnt(3)
    s_mov_b64 exec, s[48:49]
    v_bfe_u32 v164, v146, 16, 7
    v_lshl_add_u32 v164, v164, 2, s31
    ds_add_rtn_u32 v147, v164, v231
    s_waitcnt vmcnt(2)
    s_mov_b64 exec, s[50:51]
    v_bfe_u32 v165, v150, 16, 7
    v_lshl_add_u32 v165, v165, 2, s31
    ds_add_rtn_u32 v151, v165, v231
    s_waitcnt vmcnt(1)
    s_mov_b64 exec, s[52:53]
    v_bfe_u32 v166, v154, 16, 7
    v_lshl_add_u32 v166, v166, 2, s31
    ds_add_rtn_u32 v155, v166, v231
    s_waitcnt vmcnt(0)
    s_mov_b64 exec, s[54:55]
    v_bfe_u32 v167, v158, 16, 7
    v_lshl_add_u32 v167, v167, 2, s31
    ds_add_rtn_u32 v159, v167, v231
FK_HD:
    s_mov_b64 exec, -1
    s_waitcnt vmcnt(0)
    s_cmp_eq_u32 s58, 0
    s_cbranch_scc1 FK_XUD
    s_cmp_lg_u32 s67, 0
    s_cbranch_scc1 FK_XUD
    buffer_store_dword v208, v193, s[12:15], s73 offen offset:0 sc1
    buffer_store_dword v209, v193, s[12:15], s73 offen offset:128 sc1
    s_cmp_eq_u32 s59, 3
    s_cbranch_scc1 FK_XUD
    buffer_store_dword v210, v193, s[12:15], s73 offen offset:256 sc1
    buffer_store_dword v211, v193, s[12:15], s73 offen offset:384 sc1
    buffer_store_dword v212, v193, s[12:15], s73 offen offset:1024 sc1
    buffer_store_dword v213, v193, s[12:15], s73 offen offset:1152 sc1
    buffer_store_dword v214, v193, s[12:15], s73 offen offset:1280 sc1
    buffer_store_dword v215, v193, s[12:15], s73 offen offset:1408 sc1
    buffer_store_dword v216, v193, s[12:15], s73 offen offset:2048 sc1
    buffer_store_dword v217, v193, s[12:15], s73 offen offset:2176 sc1
    buffer_store_dword v218, v193, s[12:15], s73 offen offset:2304 sc1
    buffer_store_dword v219, v193, s[12:15], s73 offen offset:2432 sc1
    buffer_store_dword v220, v193, s[12:15], s73 offen offset:3072 sc1
    buffer_store_dword v221, v193, s[12:15], s73 offen offset:3200 sc1
    buffer_store_dword v222, v193, s[12:15], s73 offen offset:3328 sc1
    buffer_store_dword v223, v193, s[12:15], s73 offen offset:3456 sc1
FK_XUD:
    s_waitcnt lgkmcnt(0)
    s_barrier
    ds_read_b64 v[244:245], v241
    ds_read_b32 v243, v17
    s_waitcnt lgkmcnt(0)
    v_add_u32 v226, 3, v244
    v_add_u32 v227, 3, v245
    v_and_b32 v226, 0xfffffffc, v226
    v_and_b32 v227, 0xfffffffc, v227
    v_add_u32 v227, v226, v227
    v_mov_b32 v228, v227
    v_readfirstlane_b32 s19, v243
    s_nop 1
    v_add_u32_dpp v228, v228, v228 row_shr:1 row_mask:0xf bank_mask:0xf bound_ctrl:0
    s_nop 1
    v_add_u32_dpp v228, v228, v228 row_shr:2 row_mask:0xf bank_mask:0xf bound_ctrl:0
    s_nop 1
    v_add_u32_dpp v228, v228, v228 row_shr:4 row_mask:0xf bank_mask:0xf bound_ctrl:0
    s_nop 1
    v_add_u32_dpp v228, v228, v228 row_shr:8 row_mask:0xf bank_mask:0xf bound_ctrl:0
    s_nop 1
    v_add_u32_dpp v228, v228, v228 row_bcast:15 row_mask:0xa bank_mask:0xf
    s_nop 1
    v_add_u32_dpp v228, v228, v228 row_bcast:31 row_mask:0xc bank_mask:0xf
    v_sub_u32 v246, v228, v227
    v_add_u32 v247, v246, v226
    v_readlane_b32 s20, v228, 63
    ds_write_b64 v241, v[246:247] offset:4112
    s_cmp_lg_u32 s18, 0
    s_cbranch_scc1 FK_OK
    s_cmp_ge_u32 s19, 0x10000
    s_cbranch_scc1 FK_GOSLOW
    s_cmp_le_u32 s20, 3712
    s_cbranch_scc1 FK_OK
FK_GOSLOW:
    s_mov_b32 s18, 1
    s_mov_b32 s17, 6
    s_branch FK_REBATCH
FK_OK:
    s_mov_b64 exec, s[40:41]
    ds_read_b32 v160, v160 offset:4112
    s_mov_b64 exec, s[42:43]
    ds_read_b32 v161, v161 offset:4112
    s_mov_b64 exec, s[44:45]
    ds_read_b32 v162, v162 offset:4112
    s_mov_b64 exec, s[46:47]
    ds_read_b32 v163, v163 offset:4112
    s_mov_b64 exec, s[48:49]
    ds_read_b32 v164, v164 offset:4112
    s_mov_b64 exec, s[50:51]
    s_cbranch_execz FK_RD
    ds_read_b32 v165, v165 offset:4112
    s_mov_b64 exec, s[52:53]
    s_cbranch_execz FK_RD
    ds_read_b32 v166, v166 offset:4112
    s_mov_b64 exec, s[54:55]
    s_cbranch_execz FK_RD
    ds_read_b32 v167, v167 offset:4112
FK_RD:
    s_mov_b64 exec, -1
    s_and_b32 s19, s19, 0xffff
    s_add_u32 s26, s20, 31
    s_lshr_b32 s26, s26, 5
    s_lshl_b32 s29, s26, 5
    s_lshr_b32 s27, s26, 3
    s_and_b32 s26, s26, 7
    s_mul_i32 s22, s3, s27
    s_min_u32 s28, s3, s26
    s_add_u32 s22, s22, s28
    s_lshl_b32 s22, s22, 3
    s_cmp_lt_u32 s3, s26
    s_cselect_b32 s28, 1, 0
    s_add_u32 s21, s27, s28
    s_lshl_b32 s28, s21, 2
    s_add_u32 s23, s22, s28
    s_cmp_eq_u32 s3, 1
    s_cbranch_scc1 FK_JOBD
    s_bitcmp1_b32 s3, 0
    s_cselect_b64 s[34:35], -1, 0
    v_cndmask_b32_e64 v4, v244, v245, s[34:35]
    v_cndmask_b32_e64 v5, v246, v247, s[34:35]
    s_lshr_b32 s27, s3, 1
    v_mov_b32 v8, 0
    v_mov_b32 v9, 0
    v_mov_b32 v10, 1065353216
    s_cmp_lg_u32 s27, 0
    s_cbranch_scc1 FK_PADJOB
    v_add_u32 v5, s20, v1
    v_cmp_ge_u32 vcc, s29, v5
    s_branch FK_PADW
FK_PADJOB:
    v_sub_u32 v6, 0, v4
    v_and_b32 v6, 3, v6
    v_add3_u32 v5, v5, v4, s27
    v_add_u32 v5, -1, v5
    v_cmp_le_u32 vcc, s27, v6
FK_PADW:
    v_lshlrev_b32 v6, 3, v5
    v_add_u32 v6, 85008, v6
    v_lshlrev_b32 v7, 2, v5
    v_add_u32 v7, 114720, v7
    s_mov_b64 exec, vcc
    ds_write_b64 v6, v[8:9]
    ds_write_b32 v7, v10
    s_mov_b64 exec, -1
    s_waitcnt lgkmcnt(2)
    s_branch FK_JOBE
FK_JOBD:
    s_waitcnt lgkmcnt(0)
FK_JOBE:
    s_mov_b32 s30, 85008
    s_mov_b32 s31, 114720
    s_mov_b64 exec, s[40:41]
    v_add_u32 v160, v160, v131
    v_lshl_add_u32 v131, v160, 3, s30
    ds_write_b64 v131, v[128:129]
    v_lshl_add_u32 v160, v160, 2, s31
    v_and_b32 v130, 0xffff, v130
    ds_write_b32 v160, v130
    s_mov_b64 exec, s[42:43]
    v_add_u32 v161, v161, v135
    v_lshl_add_u32 v135, v161, 3, s30
    ds_write_b64 v135, v[132:133]
    v_lshl_add_u32 v161, v161, 2, s31
    v_and_b32 v134, 0xffff, v134
    ds_write_b32 v161, v134
    s_mov_b64 exec, s[44:45]
    v_add_u32 v162, v162, v139
    v_lshl_add_u32 v139, v162, 3, s30
    ds_write_b64 v139, v[136:137]
    v_lshl_add_u32 v162, v162, 2, s31
    v_and_b32 v138, 0xffff, v138
    ds_write_b32 v162, v138
    s_mov_b64 exec, s[46:47]
    v_add_u32 v163, v163, v143
    v_lshl_add_u32 v143, v163, 3, s30
    ds_write_b64 v143, v[140:141]
    v_lshl_add_u32 v163, v163, 2, s31
    v_and_b32 v142, 0xffff, v142
    ds_write_b32 v163, v142
    s_mov_b64 exec, s[48:49]
    v_add_u32 v164, v164, v147
    v_lshl_add_u32 v147, v164, 3, s30
    ds_write_b64 v147, v[144:145]
    v_lshl_add_u32 v164, v164, 2, s31
    v_and_b32 v146, 0xffff, v146
    ds_write_b32 v164, v146
    s_mov_b64 exec, s[50:51]
    s_cbranch_execz FK_SD
    v_add_u32 v165, v165, v151
    v_lshl_add_u32 v151, v165, 3, s30
    ds_write_b64 v151, v[148:149]
    v_lshl_add_u32 v165, v165, 2, s31
    v_and_b32 v150, 0xffff, v150
    ds_write_b32 v165, v150
    s_mov_b64 exec, s[52:53]
    s_cbranch_execz FK_SD
    v_add_u32 v166, v166, v155
    v_lshl_add_u32 v155, v166, 3, s30
    ds_write_b64 v155, v[152:153]
    v_lshl_add_u32 v166, v166, 2, s31
    v_and_b32 v154, 0xffff, v154
    ds_write_b32 v166, v154
    s_mov_b64 exec, s[54:55]
    s_cbranch_execz FK_SD
    v_add_u32 v167, v167, v159
    v_lshl_add_u32 v159, v167, 3, s30
    ds_write_b64 v159, v[156:157]
    v_lshl_add_u32 v167, v167, 2, s31
    v_and_b32 v158, 0xffff, v158
    ds_write_b32 v167, v158
FK_SD:
    s_mov_b64 exec, -1
    v_mul_u32_u24 v4, s28, v59
    v_add_u32 v4, s22, v4
    v_lshl_add_u32 v34, v4, 4, v60
    s_waitcnt lgkmcnt(0)
    s_barrier
    s_cmp_eq_u32 s21, 0
    s_cbranch_scc1 FK_LOOPDONE
    ds_read_b128 v[20:23], v34
    v_mul_u32_u24 v4, s28, v56
    v_add_u32 v4, s22, v4
    v_mad_u32_u24 v32, v4, v57, v58
    v_add_u32 v34, 64, v34
    s_waitcnt lgkmcnt(0)
    v_lshl_add_u32 v20, v20, 7, v24
    v_lshl_add_u32 v21, v21, 7, v25
    v_lshl_add_u32 v22, v22, 7, v26
    v_lshl_add_u32 v23, v23, 7, v27
    buffer_load_dwordx4 v20, s[96:99], 0 offen offset:0 lds
    buffer_load_dwordx4 v21, s[96:99], 0 offen offset:1024 lds
    buffer_load_dwordx4 v22, s[96:99], 0 offen offset:2048 lds
    buffer_load_dwordx4 v23, s[96:99], 0 offen offset:3072 lds
    ds_read2_b32 v[50:51], v32 offset0:0 offset1:1
    v_add_u32 v32, v32, v33
    s_lshl_b32 s30, s21, 3
    v_lshrrev_b32 v4, 2, v246
    v_lshrrev_b32 v5, 2, v247
    v_subrev_u32 v4, s22, v4
    v_subrev_u32 v5, s22, v5
    v_cmp_gt_u32 s[34:35], s30, v4
    v_cmp_gt_u32 s[36:37], s30, v5
    v_cmp_lt_u32 s[38:39], 0, v244
    v_cmp_lt_u32 s[58:59], 0, v245
    v_add_u32 v4, s62, v4
    v_add_u32 v5, s62, v5
    v_lshl_add_u32 v6, v1, 1, 1
    v_lshl_add_u32 v7, v1, 1, 2
    s_and_b64 exec, s[34:35], s[38:39]
    ds_write_b8 v4, v6
    s_and_b64 exec, s[36:37], s[58:59]
    ds_write_b8 v5, v7
    s_mov_b64 exec, -1
    v_mul_u32_u24 v4, s28, v3
    v_add_u32 v4, s22, v4
    v_lshl_add_u32 v240, v2, 1, v4
    s_sub_u32 s30, s62, s22
    v_add_u32 v241, s30, v240
    ds_read_u16 v5, v241
    s_lshl_b32 s30, s22, 2
    s_lshl_b32 s31, s23, 2
    v_cmp_ge_u32 s[34:35], s30, v246
    v_cmp_ge_u32 s[36:37], s30, v247
    v_cmp_ge_u32 s[38:39], s31, v246
    v_cmp_ge_u32 s[58:59], s31, v247
    ds_read_b128 v[20:23], v34
    v_add_u32 v34, 64, v34
    v_lshlrev_b32 v35, 2, v4
    v_add_u32 v35, 77584, v35
    s_bcnt1_i32_b64 s30, s[34:35]
    s_bcnt1_i32_b64 s31, s[36:37]
    s_add_u32 s56, s30, s31
    s_bcnt1_i32_b64 s30, s[38:39]
    s_bcnt1_i32_b64 s31, s[58:59]
    s_add_u32 s57, s30, s31
    v_mov_b32 v242, s56
    s_mov_b32 exec_lo, 0
    v_mov_b32 v242, s57
    s_mov_b32 exec_lo, -1
    s_lshr_b32 s20, s20, 2
    s_mov_b32 s64, -128
    s_lshl_b32 s26, s3, 1
    s_add_u32 s26, s26, 97
    v_add_u32 v10, s26, v3
    v_lshlrev_b32 v11, 1, v2
    v_cmp_gt_u32 s[38:39], s28, v11
    s_waitcnt lgkmcnt(1)
    s_nop 0
    v_cndmask_b32_e64 v4, 0, v5, s[38:39]
    v_and_b32 v5, 0xff, v4
    v_lshrrev_b32 v6, 8, v4
    v_max_u32 v7, v5, v6
    v_readlane_b32 s30, v5, 0
    v_readlane_b32 s31, v5, 32
    s_nop 1
    v_max_u32_dpp v7, v7, v7 row_shr:1 row_mask:0xf bank_mask:0xf bound_ctrl:0
    s_nop 1
    v_max_u32_dpp v7, v7, v7 row_shr:2 row_mask:0xf bank_mask:0xf bound_ctrl:0
    s_nop 1
    v_max_u32_dpp v7, v7, v7 row_shr:4 row_mask:0xf bank_mask:0xf bound_ctrl:0
    s_nop 1
    v_max_u32_dpp v7, v7, v7 row_shr:8 row_mask:0xf bank_mask:0xf bound_ctrl:0
    s_nop 1
    v_max_u32_dpp v7, v7, v7 row_bcast:15 row_mask:0xa bank_mask:0xf
    v_mov_b32 v8, 0
    s_cmp_eq_u32 s30, 0
    s_cselect_b32 s34, -1, 0
    s_cmp_lt_u32 s22, s20
    s_cselect_b32 s34, s34, 0
    v_mov_b32_dpp v8, v7 wave_shr:1 row_mask:0xf bank_mask:0xf
    s_cmp_eq_u32 s31, 0
    s_cselect_b32 s35, -1, 0
    s_cmp_lt_u32 s23, s20
    s_cselect_b32 s35, s35, 0
    v_max3_u32 v8, v8, v5, v242
    v_max_u32 v7, v7, v242
    v_add_u32 v12, 1, v10
    v_cmp_eq_u32 s[36:37], v8, v242
    v_cmp_eq_u32 s[58:59], v7, v242
    s_and_b64 s[36:37], s[36:37], s[34:35]
    s_and_b64 s[58:59], s[58:59], s[34:35]
    v_cndmask_b32_e64 v8, v8, v12, s[36:37]
    v_cndmask_b32_e64 v7, v7, v12, s[58:59]
    v_add_u32 v13, 1, v240
    v_mov_b32 v12, 114
    v_cmp_gt_u32 s[36:37], s20, v240
    v_cmp_gt_u32 s[66:67], s20, v13
    v_cmp_eq_u32 s[58:59], 0, v5
    v_cmp_eq_u32 s[60:61], 0, v6
    v_cmp_lt_u32 s[62:63], 0, v2
    v_cndmask_b32_e64 v8, v12, v8, s[36:37]
    v_cndmask_b32_e64 v7, v12, v7, s[66:67]
    s_and_b64 s[58:59], s[58:59], s[36:37]
    s_and_b64 s[58:59], s[58:59], s[62:63]
    s_and_b64 s[60:61], s[60:61], s[66:67]
    v_mul_u32_u24 v224, 640, v8
    v_mul_u32_u24 v225, 640, v7
    v_add_u32 v224, -640, v224
    v_add_u32 v225, -640, v225
    v_cndmask_b32_e64 v226, 0, 1.0, s[58:59]
    v_cndmask_b32_e64 v227, 0, 1.0, s[60:61]
    v_lshlrev_b32 v13, 2, v240
    v_add_u32 v13, 77584, v13
    s_mov_b64 exec, s[38:39]
    ds_write_b64 v13, v[224:225]
    ds_write_b64 v13, v[226:227] offset:3712
    s_and_b64 exec, s[34:35], s[34:35]
    s_cbranch_execz FK_NOCONT
    v_mul_u32_u24 v14, 640, v242
    v_add3_u32 v14, v14, v36, s64
    ds_read_b32 v15, v14
    v_mul_u32_u24 v14, 640, v10
    v_add_u32 v14, v14, v36
    v_lshlrev_b32 v13, 2, v242
    v_add_u32 v13, 73468, v13
    s_waitcnt lgkmcnt(0)
    ds_write_b32 v14, v15 offset:512
    s_and_b32 exec_lo, exec_lo, 1
    s_and_b32 exec_hi, exec_hi, 1
    ds_max_u32 v13, v10
    ds_min_u32 v13, v10 offset:528
FK_NOCONT:
    s_mov_b64 exec, -1
    ds_read_b128 v[12:15], v35 offset:0
    ds_read_b128 v[4:7], v35 offset:3712
    s_nand_b32 s30, s60, s61
    s_nand_b32 s31, s58, s59
    s_lshr_b32 s31, s31, 1
    s_bitreplicate_b64_b32 s[44:45], s30
    s_bitreplicate_b64_b32 s[46:47], s31
    s_mov_b32 s30, 0x55555555
    s_mov_b32 s31, 0x55555555
    s_and_b64 s[44:45], s[44:45], s[30:31]
    s_andn2_b64 s[46:47], s[46:47], s[30:31]
    s_or_b64 s[44:45], s[44:45], s[46:47]
    s_sub_u32 s30, s28, 1
    s_bitset1_b64 s[44:45], s30
    v_mov_b32 v243, 0
    v_mov_b32 v251, 0
    v_mov_b32 v247, 0
    v_mov_b32 v255, 0
    s_waitcnt lgkmcnt(0)
    v_add_u32 v12, v12, v36
    v_add_u32 v13, v13, v36
    v_add_u32 v14, v14, v36
    v_add_u32 v15, v15, v36
    ds_read_b32 v40, v12 offset:512
    ds_read_b32 v41, v13 offset:512
    ds_read_b32 v42, v14 offset:512
    ds_read_b32 v43, v15 offset:512
    s_waitcnt vmcnt(0)
    ds_read_b128 v[192:195], v28
    ds_read_b128 v[196:199], v29
    ds_read_b128 v[200:203], v30
    ds_read_b128 v[204:207], v31
    v_lshl_add_u32 v20, v20, 7, v24
    v_lshl_add_u32 v21, v21, 7, v25
    v_lshl_add_u32 v22, v22, 7, v26
    v_lshl_add_u32 v23, v23, 7, v27
    s_waitcnt lgkmcnt(0)
    s_cmp_lt_u32 s21, 2
    s_cbranch_scc1 FK_SKD0
    buffer_load_dwordx4 v20, s[96:99], 0 offen offset:0 lds
    buffer_load_dwordx4 v21, s[96:99], 0 offen offset:1024 lds
    buffer_load_dwordx4 v22, s[96:99], 0 offen offset:2048 lds
    buffer_load_dwordx4 v23, s[96:99], 0 offen offset:3072 lds
FK_SKD0:
    v_perm_b32 v44, v41, v40, s74
    v_perm_b32 v45, v43, v42, s74
    v_perm_b32 v52, v41, v40, s75
    v_perm_b32 v53, v43, v42, s75
    ds_read_b128 v[12:15], v35 offset:16
    ds_read_b128 v[20:23], v34
    v_mfma_f32_32x32x16_bf16 v[128:143], v[192:195], v[64:67], 0
    v_mfma_f32_32x32x16_bf16 v[128:143], v[196:199], v[72:75], v[128:143]
    v_mfma_f32_32x32x16_bf16 v[128:143], v[200:203], v[80:83], v[128:143]
    v_mfma_f32_32x32x16_bf16 v[128:143], v[204:207], v[88:91], v[128:143]
    v_mfma_f32_32x32x16_bf16 v[128:143], v[48:51], v[44:47], v[128:143]
    v_add_u32 v34, 64, v34
    v_mfma_f32_32x32x16_bf16 v[224:239], v[192:195], v[68:71], 0
    v_mfma_f32_32x32x16_bf16 v[224:239], v[196:199], v[76:79], v[224:239]
    v_mfma_f32_32x32x16_bf16 v[224:239], v[200:203], v[84:87], v[224:239]
    v_mfma_f32_32x32x16_bf16 v[224:239], v[204:207], v[92:95], v[224:239]
    v_mfma_f32_32x32x16_bf16 v[224:239], v[48:51], v[52:55], v[224:239]
    s_waitcnt lgkmcnt(0)
    v_add_u32 v12, v12, v36
    v_add_u32 v13, v13, v36
    v_add_u32 v14, v14, v36
    v_add_u32 v15, v15, v36
    ds_read2_b32 v[50:51], v32 offset0:0 offset1:1
    ds_read_b32 v40, v12 offset:512
    ds_read_b32 v41, v13 offset:512
    ds_read_b32 v42, v14 offset:512
    ds_read_b32 v43, v15 offset:512
    v_lshl_add_u32 v20, v20, 7, v24
    v_lshl_add_u32 v21, v21, 7, v25
    v_lshl_add_u32 v22, v22, 7, v26
    v_lshl_add_u32 v23, v23, 7, v27
    v_exp_f32 v144, v128
    v_exp_f32 v145, v129
    v_exp_f32 v146, v130
    v_exp_f32 v147, v131
    v_exp_f32 v148, v132
    v_exp_f32 v149, v133
    v_exp_f32 v150, v134
    v_exp_f32 v151, v135
    v_exp_f32 v152, v136
    v_exp_f32 v153, v137
    v_exp_f32 v154, v138
    v_exp_f32 v155, v139
    v_exp_f32 v156, v140
    v_exp_f32 v157, v141
    v_exp_f32 v158, v142
    v_exp_f32 v159, v143
    s_waitcnt vmcnt(0)
    ds_read_b128 v[208:211], v28
    ds_read_b128 v[212:215], v29
    ds_read_b128 v[216:219], v30
    ds_read_b128 v[220:223], v31
    v_add_f32 v144, 1.0, v144
    v_add_f32 v145, 1.0, v145
    v_add_f32 v146, 1.0, v146
    v_add_f32 v147, 1.0, v147
    v_add_f32 v148, 1.0, v148
    v_add_f32 v149, 1.0, v149
    v_add_f32 v150, 1.0, v150
    v_add_f32 v151, 1.0, v151
    v_add_f32 v152, 1.0, v152
    v_add_f32 v153, 1.0, v153
    v_add_f32 v154, 1.0, v154
    v_add_f32 v155, 1.0, v155
    v_add_f32 v156, 1.0, v156
    v_add_f32 v157, 1.0, v157
    v_add_f32 v158, 1.0, v158
    v_add_f32 v159, 1.0, v159
    s_waitcnt lgkmcnt(0)
    s_cmp_lt_u32 s21, 3
    s_cbranch_scc1 FK_SKD1
    buffer_load_dwordx4 v20, s[96:99], 0 offen offset:0 lds
    buffer_load_dwordx4 v21, s[96:99], 0 offen offset:1024 lds
    buffer_load_dwordx4 v22, s[96:99], 0 offen offset:2048 lds
    buffer_load_dwordx4 v23, s[96:99], 0 offen offset:3072 lds
FK_SKD1:
    ds_read_b128 v[20:23], v34
    s_sub_u32 s25, s21, 1
FK_LOOP:
    s_cmp_eq_u32 s25, 0
    s_cbranch_scc1 FK_LAST0
    s_waitcnt lgkmcnt(0)
    s_setprio 1
    v_mfma_f32_32x32x16_bf16 v[128:143], v[208:211], v[64:67], 0
    v_exp_f32 v160, v224
    v_perm_b32 v44, v41, v40, s74
    v_perm_b32 v45, v43, v42, s74
    v_exp_f32 v161, v225
    v_exp_f32 v162, v226
    v_mfma_f32_32x32x16_bf16 v[128:143], v[212:215], v[72:75], v[128:143]
    v_exp_f32 v163, v227
    v_exp_f32 v164, v228
    v_perm_b32 v52, v41, v40, s75
    v_perm_b32 v53, v43, v42, s75
    v_exp_f32 v165, v229
    v_mfma_f32_32x32x16_bf16 v[128:143], v[216:219], v[80:83], v[128:143]
    v_exp_f32 v166, v230
    v_exp_f32 v167, v231
    v_exp_f32 v168, v232
    v_mfma_f32_32x32x16_bf16 v[128:143], v[220:223], v[88:91], v[128:143]
    v_exp_f32 v169, v233
    v_exp_f32 v170, v234
    v_exp_f32 v171, v235
    v_mfma_f32_32x32x16_bf16 v[128:143], v[48:51], v[44:47], v[128:143]
    v_exp_f32 v172, v236
    v_exp_f32 v173, v237
    v_exp_f32 v174, v238
    v_mfma_f32_32x32x16_bf16 v[176:191], v[192:195], v[96:99], 0
    v_exp_f32 v175, v239
    v_rcp_f32 v144, v144
    v_rcp_f32 v145, v145
    v_mfma_f32_32x32x16_bf16 v[176:191], v[196:199], v[104:107], v[176:191]
    v_rcp_f32 v146, v146
    v_rcp_f32 v147, v147
    v_rcp_f32 v148, v148
    v_mfma_f32_32x32x16_bf16 v[176:191], v[200:203], v[112:115], v[176:191]
    v_rcp_f32 v149, v149
    v_rcp_f32 v150, v150
    v_rcp_f32 v151, v151
    v_mfma_f32_32x32x16_bf16 v[176:191], v[204:207], v[120:123], v[176:191]
    v_rcp_f32 v152, v152
    v_rcp_f32 v153, v153
    v_rcp_f32 v154, v154
    v_rcp_f32 v155, v155
    v_rcp_f32 v156, v156
    v_rcp_f32 v157, v157
    v_lshl_add_u32 v20, v20, 7, v24
    v_lshl_add_u32 v21, v21, 7, v25
    v_lshl_add_u32 v22, v22, 7, v26
    v_lshl_add_u32 v23, v23, 7, v27
    v_rcp_f32 v158, v158
    v_rcp_f32 v159, v159
    s_setprio 0
    ds_read_b128 v[8:11], v35 offset:3728
    ds_read_b128 v[12:15], v35 offset:32
    v_add_f32 v160, 1.0, v160
    v_add_f32 v161, 1.0, v161
    v_add_f32 v162, 1.0, v162
    v_add_f32 v163, 1.0, v163
    v_add_f32 v164, 1.0, v164
    v_add_f32 v165, 1.0, v165
    v_add_f32 v166, 1.0, v166
    v_add_f32 v167, 1.0, v167
    v_add_f32 v168, 1.0, v168
    v_add_f32 v169, 1.0, v169
    v_add_f32 v170, 1.0, v170
    v_add_f32 v171, 1.0, v171
    v_add_f32 v172, 1.0, v172
    v_add_f32 v173, 1.0, v173
    v_add_f32 v174, 1.0, v174
    v_add_f32 v175, 1.0, v175
    v_mul_f32 v244, v247, v4
    v_fma_f32 v240, v243, v4, v144
    v_fmac_f32 v244, v144, v176
    v_add_f32 v240, v240, v145
    v_fmac_f32 v244, v145, v177
    v_add_f32 v240, v240, v146
    v_fmac_f32 v244, v146, v178
    v_add_f32 v240, v240, v147
    v_fmac_f32 v244, v147, v179
    v_mul_f32 v245, v244, v5
    v_fma_f32 v241, v240, v5, v148
    v_fmac_f32 v245, v148, v180
    v_add_f32 v241, v241, v149
    v_fmac_f32 v245, v149, v181
    v_add_f32 v241, v241, v150
    v_fmac_f32 v245, v150, v182
    v_add_f32 v241, v241, v151
    v_fmac_f32 v245, v151, v183
    v_mul_f32 v246, v245, v6
    v_fma_f32 v242, v241, v6, v152
    v_fmac_f32 v246, v152, v184
    v_add_f32 v242, v242, v153
    v_fmac_f32 v246, v153, v185
    v_add_f32 v242, v242, v154
    s_waitcnt lgkmcnt(0)
    v_add_u32 v12, v12, v36
    v_add_u32 v13, v13, v36
    v_add_u32 v14, v14, v36
    v_add_u32 v15, v15, v36
    v_add_u32 v32, v32, v33
    v_add_u32 v34, 64, v34
    v_fmac_f32 v246, v154, v186
    v_add_f32 v242, v242, v155
    v_fmac_f32 v246, v155, v187
    v_mul_f32 v247, v246, v7
    v_fma_f32 v243, v242, v7, v156
    v_fmac_f32 v247, v156, v188
    v_add_f32 v243, v243, v157
    v_fmac_f32 v247, v157, v189
    v_add_f32 v243, v243, v158
    v_fmac_f32 v247, v158, v190
    v_add_f32 v243, v243, v159
    v_fmac_f32 v247, v159, v191
    s_setprio 1
    v_mfma_f32_32x32x16_bf16 v[224:239], v[208:211], v[68:71], 0
    v_exp_f32 v144, v128
    v_exp_f32 v145, v129
    v_exp_f32 v146, v130
    v_mfma_f32_32x32x16_bf16 v[224:239], v[212:215], v[76:79], v[224:239]
    v_exp_f32 v147, v131
    v_exp_f32 v148, v132
    v_exp_f32 v149, v133
    v_mfma_f32_32x32x16_bf16 v[224:239], v[216:219], v[84:87], v[224:239]
    v_exp_f32 v150, v134
    v_exp_f32 v151, v135
    v_exp_f32 v152, v136
    v_mfma_f32_32x32x16_bf16 v[224:239], v[220:223], v[92:95], v[224:239]
    v_exp_f32 v153, v137
    v_exp_f32 v154, v138
    v_exp_f32 v155, v139
    v_mfma_f32_32x32x16_bf16 v[224:239], v[48:51], v[52:55], v[224:239]
    v_exp_f32 v156, v140
    v_exp_f32 v157, v141
    v_exp_f32 v158, v142
    v_mfma_f32_32x32x16_bf16 v[176:191], v[192:195], v[100:103], 0
    v_exp_f32 v159, v143
    v_rcp_f32 v160, v160
    v_rcp_f32 v161, v161
    v_mfma_f32_32x32x16_bf16 v[176:191], v[196:199], v[108:111], v[176:191]
    v_rcp_f32 v162, v162
    v_rcp_f32 v163, v163
    v_rcp_f32 v164, v164
    v_mfma_f32_32x32x16_bf16 v[176:191], v[200:203], v[116:119], v[176:191]
    v_rcp_f32 v165, v165
    v_rcp_f32 v166, v166
    v_rcp_f32 v167, v167
    v_mfma_f32_32x32x16_bf16 v[176:191], v[204:207], v[124:127], v[176:191]
    v_rcp_f32 v168, v168
    v_rcp_f32 v169, v169
    v_rcp_f32 v170, v170
    v_rcp_f32 v171, v171
    v_rcp_f32 v172, v172
    v_rcp_f32 v173, v173
    v_rcp_f32 v174, v174
    v_rcp_f32 v175, v175
    s_setprio 0
    s_waitcnt vmcnt(0)
    ds_read_b128 v[192:195], v28
    ds_read_b128 v[196:199], v29
    ds_read_b128 v[200:203], v30
    ds_read_b128 v[204:207], v31
    ds_read2_b32 v[50:51], v32 offset0:0 offset1:1
    ds_read_b32 v40, v12 offset:512
    ds_read_b32 v41, v13 offset:512
    ds_read_b32 v42, v14 offset:512
    ds_read_b32 v43, v15 offset:512
    ds_read_b128 v[12:15], v35 offset:0
    v_add_f32 v144, 1.0, v144
    v_add_f32 v145, 1.0, v145
    v_add_f32 v146, 1.0, v146
    v_add_f32 v147, 1.0, v147
    v_add_f32 v148, 1.0, v148
    v_add_f32 v149, 1.0, v149
    v_add_f32 v150, 1.0, v150
    v_add_f32 v151, 1.0, v151
    v_add_f32 v152, 1.0, v152
    v_add_f32 v153, 1.0, v153
    v_add_f32 v154, 1.0, v154
    v_add_f32 v155, 1.0, v155
    v_add_f32 v156, 1.0, v156
    v_add_f32 v157, 1.0, v157
    v_add_f32 v158, 1.0, v158
    v_add_f32 v159, 1.0, v159
    v_mul_f32 v252, v255, v4
    v_fma_f32 v248, v251, v4, v160
    v_fmac_f32 v252, v160, v176
    v_add_f32 v248, v248, v161
    v_fmac_f32 v252, v161, v177
    v_add_f32 v248, v248, v162
    v_fmac_f32 v252, v162, v178
    v_add_f32 v248, v248, v163
    v_fmac_f32 v252, v163, v179
    v_mul_f32 v253, v252, v5
    v_fma_f32 v249, v248, v5, v164
    v_fmac_f32 v253, v164, v180
    v_add_f32 v249, v249, v165
    v_fmac_f32 v253, v165, v181
    s_waitcnt lgkmcnt(6)
    buffer_load_dwordx4 v20, s[96:99], 0 offen offset:0 lds
    buffer_load_dwordx4 v21, s[96:99], 0 offen offset:1024 lds
    buffer_load_dwordx4 v22, s[96:99], 0 offen offset:2048 lds
    buffer_load_dwordx4 v23, s[96:99], 0 offen offset:3072 lds
    ds_read_b128 v[20:23], v34
    v_add_f32 v249, v249, v166
    v_fmac_f32 v253, v166, v182
    v_add_f32 v249, v249, v167
    v_fmac_f32 v253, v167, v183
    v_mul_f32 v254, v253, v6
    v_fma_f32 v250, v249, v6, v168
    v_fmac_f32 v254, v168, v184
    v_add_f32 v250, v250, v169
    v_fmac_f32 v254, v169, v185
    v_add_f32 v250, v250, v170
    v_fmac_f32 v254, v170, v186
    v_add_f32 v250, v250, v171
    v_fmac_f32 v254, v171, v187
    v_mul_f32 v255, v254, v7
    v_fma_f32 v251, v250, v7, v172
    v_fmac_f32 v255, v172, v188
    v_add_f32 v251, v251, v173
    v_fmac_f32 v255, v173, v189
    v_add_f32 v251, v251, v174
    v_fmac_f32 v255, v174, v190
    v_add_f32 v251, v251, v175
    v_fmac_f32 v255, v175, v191
    s_and_b32 s30, s44, 15
    s_cbranch_scc1 FKQ_1S
FKQ_1:
    s_lshr_b64 s[44:45], s[44:45], 4
    v_add_u32 v35, 16, v35
    s_sub_u32 s25, s25, 1
    s_cmp_eq_u32 s25, 0
    s_cbranch_scc1 FK_LAST1
    s_waitcnt lgkmcnt(0)
    s_setprio 1
    v_mfma_f32_32x32x16_bf16 v[128:143], v[192:195], v[64:67], 0
    v_exp_f32 v160, v224
    v_perm_b32 v44, v41, v40, s74
    v_perm_b32 v45, v43, v42, s74
    v_exp_f32 v161, v225
    v_exp_f32 v162, v226
    v_mfma_f32_32x32x16_bf16 v[128:143], v[196:199], v[72:75], v[128:143]
    v_exp_f32 v163, v227
    v_exp_f32 v164, v228
    v_perm_b32 v52, v41, v40, s75
    v_perm_b32 v53, v43, v42, s75
    v_exp_f32 v165, v229
    v_mfma_f32_32x32x16_bf16 v[128:143], v[200:203], v[80:83], v[128:143]
    v_exp_f32 v166, v230
    v_exp_f32 v167, v231
    v_exp_f32 v168, v232
    v_mfma_f32_32x32x16_bf16 v[128:143], v[204:207], v[88:91], v[128:143]
    v_exp_f32 v169, v233
    v_exp_f32 v170, v234
    v_exp_f32 v171, v235
    v_mfma_f32_32x32x16_bf16 v[128:143], v[48:51], v[44:47], v[128:143]
    v_exp_f32 v172, v236
    v_exp_f32 v173, v237
    v_exp_f32 v174, v238
    v_mfma_f32_32x32x16_bf16 v[176:191], v[208:211], v[96:99], 0
    v_exp_f32 v175, v239
    v_rcp_f32 v144, v144
    v_rcp_f32 v145, v145
    v_mfma_f32_32x32x16_bf16 v[176:191], v[212:215], v[104:107], v[176:191]
    v_rcp_f32 v146, v146
    v_rcp_f32 v147, v147
    v_rcp_f32 v148, v148
    v_mfma_f32_32x32x16_bf16 v[176:191], v[216:219], v[112:115], v[176:191]
    v_rcp_f32 v149, v149
    v_rcp_f32 v150, v150
    v_rcp_f32 v151, v151
    v_mfma_f32_32x32x16_bf16 v[176:191], v[220:223], v[120:123], v[176:191]
    v_rcp_f32 v152, v152
    v_rcp_f32 v153, v153
    v_rcp_f32 v154, v154
    v_rcp_f32 v155, v155
    v_rcp_f32 v156, v156
    v_rcp_f32 v157, v157
    v_lshl_add_u32 v20, v20, 7, v24
    v_lshl_add_u32 v21, v21, 7, v25
    v_lshl_add_u32 v22, v22, 7, v26
    v_lshl_add_u32 v23, v23, 7, v27
    v_rcp_f32 v158, v158
    v_rcp_f32 v159, v159
    s_setprio 0
    ds_read_b128 v[4:7], v35 offset:3728
    ds_read_b128 v[12:15], v35 offset:32
    v_add_f32 v160, 1.0, v160
    v_add_f32 v161, 1.0, v161
    v_add_f32 v162, 1.0, v162
    v_add_f32 v163, 1.0, v163
    v_add_f32 v164, 1.0, v164
    v_add_f32 v165, 1.0, v165
    v_add_f32 v166, 1.0, v166
    v_add_f32 v167, 1.0, v167
    v_add_f32 v168, 1.0, v168
    v_add_f32 v169, 1.0, v169
    v_add_f32 v170, 1.0, v170
    v_add_f32 v171, 1.0, v171
    v_add_f32 v172, 1.0, v172
    v_add_f32 v173, 1.0, v173
    v_add_f32 v174, 1.0, v174
    v_add_f32 v175, 1.0, v175
    v_mul_f32 v244, v247, v8
    v_fma_f32 v240, v243, v8, v144
    v_fmac_f32 v244, v144, v176
    v_add_f32 v240, v240, v145
    v_fmac_f32 v244, v145, v177
    v_add_f32 v240, v240, v146
    v_fmac_f32 v244, v146, v178
    v_add_f32 v240, v240, v147
    v_fmac_f32 v244, v147, v179
    v_mul_f32 v245, v244, v9
    v_fma_f32 v241, v240, v9, v148
    v_fmac_f32 v245, v148, v180
    v_add_f32 v241, v241, v149
    v_fmac_f32 v245, v149, v181
    v_add_f32 v241, v241, v150
    v_fmac_f32 v245, v150, v182
    v_add_f32 v241, v241, v151
    v_fmac_f32 v245, v151, v183
    v_mul_f32 v246, v245, v10
    v_fma_f32 v242, v241, v10, v152
    v_fmac_f32 v246, v152, v184
    v_add_f32 v242, v242, v153
    v_fmac_f32 v246, v153, v185
    v_add_f32 v242, v242, v154
    s_waitcnt lgkmcnt(0)
    v_add_u32 v12, v12, v36
    v_add_u32 v13, v13, v36
    v_add_u32 v14, v14, v36
    v_add_u32 v15, v15, v36
    v_add_u32 v32, v32, v33
    v_add_u32 v34, 64, v34
    v_fmac_f32 v246, v154, v186
    v_add_f32 v242, v242, v155
    v_fmac_f32 v246, v155, v187
    v_mul_f32 v247, v246, v11
    v_fma_f32 v243, v242, v11, v156
    v_fmac_f32 v247, v156, v188
    v_add_f32 v243, v243, v157
    v_fmac_f32 v247, v157, v189
    v_add_f32 v243, v243, v158
    v_fmac_f32 v247, v158, v190
    v_add_f32 v243, v243, v159
    v_fmac_f32 v247, v159, v191
    s_setprio 1
    v_mfma_f32_32x32x16_bf16 v[224:239], v[192:195], v[68:71], 0
    v_exp_f32 v144, v128
    v_exp_f32 v145, v129
    v_exp_f32 v146, v130
    v_mfma_f32_32x32x16_bf16 v[224:239], v[196:199], v[76:79], v[224:239]
    v_exp_f32 v147, v131
    v_exp_f32 v148, v132
    v_exp_f32 v149, v133
    v_mfma_f32_32x32x16_bf16 v[224:239], v[200:203], v[84:87], v[224:239]
    v_exp_f32 v150, v134
    v_exp_f32 v151, v135
    v_exp_f32 v152, v136
    v_mfma_f32_32x32x16_bf16 v[224:239], v[204:207], v[92:95], v[224:239]
    v_exp_f32 v153, v137
    v_exp_f32 v154, v138
    v_exp_f32 v155, v139
    v_mfma_f32_32x32x16_bf16 v[224:239], v[48:51], v[52:55], v[224:239]
    v_exp_f32 v156, v140
    v_exp_f32 v157, v141
    v_exp_f32 v158, v142
    v_mfma_f32_32x32x16_bf16 v[176:191], v[208:211], v[100:103], 0
    v_exp_f32 v159, v143
    v_rcp_f32 v160, v160
    v_rcp_f32 v161, v161
    v_mfma_f32_32x32x16_bf16 v[176:191], v[212:215], v[108:111], v[176:191]
    v_rcp_f32 v162, v162
    v_rcp_f32 v163, v163
    v_rcp_f32 v164, v164
    v_mfma_f32_32x32x16_bf16 v[176:191], v[216:219], v[116:119], v[176:191]
    v_rcp_f32 v165, v165
    v_rcp_f32 v166, v166
    v_rcp_f32 v167, v167
    v_mfma_f32_32x32x16_bf16 v[176:191], v[220:223], v[124:127], v[176:191]
    v_rcp_f32 v168, v168
    v_rcp_f32 v169, v169
    v_rcp_f32 v170, v170
    v_rcp_f32 v171, v171
    v_rcp_f32 v172, v172
    v_rcp_f32 v173, v173
    v_rcp_f32 v174, v174
    v_rcp_f32 v175, v175
    s_setprio 0
    s_waitcnt vmcnt(0)
    ds_read_b128 v[208:211], v28
    ds_read_b128 v[212:215], v29
    ds_read_b128 v[216:219], v30
    ds_read_b128 v[220:223], v31
    ds_read2_b32 v[50:51], v32 offset0:0 offset1:1
    ds_read_b32 v40, v12 offset:512
    ds_read_b32 v41, v13 offset:512
    ds_read_b32 v42, v14 offset:512
    ds_read_b32 v43, v15 offset:512
    ds_read_b128 v[12:15], v35 offset:0
    v_add_f32 v144, 1.0, v144
    v_add_f32 v145, 1.0, v145
    v_add_f32 v146, 1.0, v146
    v_add_f32 v147, 1.0, v147
    v_add_f32 v148, 1.0, v148
    v_add_f32 v149, 1.0, v149
    v_add_f32 v150, 1.0, v150
    v_add_f32 v151, 1.0, v151
    v_add_f32 v152, 1.0, v152
    v_add_f32 v153, 1.0, v153
    v_add_f32 v154, 1.0, v154
    v_add_f32 v155, 1.0, v155
    v_add_f32 v156, 1.0, v156
    v_add_f32 v157, 1.0, v157
    v_add_f32 v158, 1.0, v158
    v_add_f32 v159, 1.0, v159
    v_mul_f32 v252, v255, v8
    v_fma_f32 v248, v251, v8, v160
    v_fmac_f32 v252, v160, v176
    v_add_f32 v248, v248, v161
    v_fmac_f32 v252, v161, v177
    v_add_f32 v248, v248, v162
    v_fmac_f32 v252, v162, v178
    v_add_f32 v248, v248, v163
    v_fmac_f32 v252, v163, v179
    v_mul_f32 v253, v252, v9
    v_fma_f32 v249, v248, v9, v164
    v_fmac_f32 v253, v164, v180
    v_add_f32 v249, v249, v165
    v_fmac_f32 v253, v165, v181
    s_waitcnt lgkmcnt(6)
    buffer_load_dwordx4 v20, s[96:99], 0 offen offset:0 lds
    buffer_load_dwordx4 v21, s[96:99], 0 offen offset:1024 lds
    buffer_load_dwordx4 v22, s[96:99], 0 offen offset:2048 lds
    buffer_load_dwordx4 v23, s[96:99], 0 offen offset:3072 lds
    ds_read_b128 v[20:23], v34
    v_add_f32 v249, v249, v166
    v_fmac_f32 v253, v166, v182
    v_add_f32 v249, v249, v167
    v_fmac_f32 v253, v167, v183
    v_mul_f32 v254, v253, v10
    v_fma_f32 v250, v249, v10, v168
    v_fmac_f32 v254, v168, v184
    v_add_f32 v250, v250, v169
    v_fmac_f32 v254, v169, v185
    v_add_f32 v250, v250, v170
    v_fmac_f32 v254, v170, v186
    v_add_f32 v250, v250, v171
    v_fmac_f32 v254, v171, v187
    v_mul_f32 v255, v254, v11
    v_fma_f32 v251, v250, v11, v172
    v_fmac_f32 v255, v172, v188
    v_add_f32 v251, v251, v173
    v_fmac_f32 v255, v173, v189
    v_add_f32 v251, v251, v174
    v_fmac_f32 v255, v174, v190
    v_add_f32 v251, v251, v175
    v_fmac_f32 v255, v175, v191
    s_and_b32 s30, s44, 15
    s_cbranch_scc1 FKQ_2S
FKQ_2:
    s_lshr_b64 s[44:45], s[44:45], 4
    v_add_u32 v35, 16, v35
    s_sub_u32 s25, s25, 1
    s_branch FK_LOOP
FKQ_1S:
    s_waitcnt lgkmcnt(1)
    s_bitcmp1_b32 s44, 0
    s_cbranch_scc0 FKQ_1_0
    v_add_u32 v37, v12, v36
    ds_write2_b32 v37, v240, v248 offset0:0 offset1:32
    ds_write2_b32 v37, v244, v252 offset0:64 offset1:96
FKQ_1_0:
    s_bitcmp1_b32 s44, 1
    s_cbranch_scc0 FKQ_1_1
    v_add_u32 v37, v13, v36
    ds_write2_b32 v37, v241, v249 offset0:0 offset1:32
    ds_write2_b32 v37, v245, v253 offset0:64 offset1:96
FKQ_1_1:
    s_bitcmp1_b32 s44, 2
    s_cbranch_scc0 FKQ_1_2
    v_add_u32 v37, v14, v36
    ds_write2_b32 v37, v242, v250 offset0:0 offset1:32
    ds_write2_b32 v37, v246, v254 offset0:64 offset1:96
FKQ_1_2:
    s_bitcmp1_b32 s44, 3
    s_cbranch_scc0 FKQ_1_3
    v_add_u32 v37, v15, v36
    ds_write2_b32 v37, v243, v251 offset0:0 offset1:32
    ds_write2_b32 v37, v247, v255 offset0:64 offset1:96
FKQ_1_3:
    s_branch FKQ_1
FKQ_2S:
    s_waitcnt lgkmcnt(1)
    s_bitcmp1_b32 s44, 0
    s_cbranch_scc0 FKQ_2_0
    v_add_u32 v37, v12, v36
    ds_write2_b32 v37, v240, v248 offset0:0 offset1:32
    ds_write2_b32 v37, v244, v252 offset0:64 offset1:96
FKQ_2_0:
    s_bitcmp1_b32 s44, 1
    s_cbranch_scc0 FKQ_2_1
    v_add_u32 v37, v13, v36
    ds_write2_b32 v37, v241, v249 offset0:0 offset1:32
    ds_write2_b32 v37, v245, v253 offset0:64 offset1:96
FKQ_2_1:
    s_bitcmp1_b32 s44, 2
    s_cbranch_scc0 FKQ_2_2
    v_add_u32 v37, v14, v36
    ds_write2_b32 v37, v242, v250 offset0:0 offset1:32
    ds_write2_b32 v37, v246, v254 offset0:64 offset1:96
FKQ_2_2:
    s_bitcmp1_b32 s44, 3
    s_cbranch_scc0 FKQ_2_3
    v_add_u32 v37, v15, v36
    ds_write2_b32 v37, v243, v251 offset0:0 offset1:32
    ds_write2_b32 v37, v247, v255 offset0:64 offset1:96
FKQ_2_3:
    s_branch FKQ_2
FK_LAST0:
    s_setprio 1
    v_mfma_f32_32x32x16_bf16 v[176:191], v[192:195], v[96:99], 0
    v_exp_f32 v160, v224
    v_exp_f32 v161, v225
    v_exp_f32 v162, v226
    v_exp_f32 v163, v227
    v_mfma_f32_32x32x16_bf16 v[176:191], v[196:199], v[104:107], v[176:191]
    v_exp_f32 v164, v228
    v_exp_f32 v165, v229
    v_exp_f32 v166, v230
    v_exp_f32 v167, v231
    v_mfma_f32_32x32x16_bf16 v[176:191], v[200:203], v[112:115], v[176:191]
    v_exp_f32 v168, v232
    v_exp_f32 v169, v233
    v_exp_f32 v170, v234
    v_exp_f32 v171, v235
    v_mfma_f32_32x32x16_bf16 v[176:191], v[204:207], v[120:123], v[176:191]
    v_exp_f32 v172, v236
    v_exp_f32 v173, v237
    v_exp_f32 v174, v238
    v_exp_f32 v175, v239
    v_rcp_f32 v144, v144
    v_rcp_f32 v145, v145
    v_rcp_f32 v146, v146
    v_rcp_f32 v147, v147
    v_rcp_f32 v148, v148
    v_rcp_f32 v149, v149
    v_rcp_f32 v150, v150
    v_rcp_f32 v151, v151
    v_rcp_f32 v152, v152
    v_rcp_f32 v153, v153
    v_rcp_f32 v154, v154
    v_rcp_f32 v155, v155
    v_rcp_f32 v156, v156
    v_rcp_f32 v157, v157
    v_rcp_f32 v158, v158
    v_rcp_f32 v159, v159
    s_setprio 0
    v_add_f32 v160, 1.0, v160
    v_add_f32 v161, 1.0, v161
    v_add_f32 v162, 1.0, v162
    v_add_f32 v163, 1.0, v163
    v_add_f32 v164, 1.0, v164
    v_add_f32 v165, 1.0, v165
    v_add_f32 v166, 1.0, v166
    v_add_f32 v167, 1.0, v167
    v_add_f32 v168, 1.0, v168
    v_add_f32 v169, 1.0, v169
    v_add_f32 v170, 1.0, v170
    v_add_f32 v171, 1.0, v171
    v_add_f32 v172, 1.0, v172
    v_add_f32 v173, 1.0, v173
    v_add_f32 v174, 1.0, v174
    v_add_f32 v175, 1.0, v175
    v_mul_f32 v244, v247, v4
    v_fma_f32 v240, v243, v4, v144
    v_fmac_f32 v244, v144, v176
    v_add_f32 v240, v240, v145
    v_fmac_f32 v244, v145, v177
    v_add_f32 v240, v240, v146
    v_fmac_f32 v244, v146, v178
    v_add_f32 v240, v240, v147
    v_fmac_f32 v244, v147, v179
    v_mul_f32 v245, v244, v5
    v_fma_f32 v241, v240, v5, v148
    v_fmac_f32 v245, v148, v180
    v_add_f32 v241, v241, v149
    v_fmac_f32 v245, v149, v181
    v_add_f32 v241, v241, v150
    v_fmac_f32 v245, v150, v182
    v_add_f32 v241, v241, v151
    v_fmac_f32 v245, v151, v183
    v_mul_f32 v246, v245, v6
    v_fma_f32 v242, v241, v6, v152
    v_fmac_f32 v246, v152, v184
    v_add_f32 v242, v242, v153
    v_fmac_f32 v246, v153, v185
    v_add_f32 v242, v242, v154
    v_fmac_f32 v246, v154, v186
    v_add_f32 v242, v242, v155
    v_fmac_f32 v246, v155, v187
    v_mul_f32 v247, v246, v7
    v_fma_f32 v243, v242, v7, v156
    v_fmac_f32 v247, v156, v188
    v_add_f32 v243, v243, v157
    v_fmac_f32 v247, v157, v189
    v_add_f32 v243, v243, v158
    v_fmac_f32 v247, v158, v190
    v_add_f32 v243, v243, v159
    v_fmac_f32 v247, v159, v191
    s_setprio 1
    v_mfma_f32_32x32x16_bf16 v[176:191], v[192:195], v[100:103], 0
    v_rcp_f32 v160, v160
    v_rcp_f32 v161, v161
    v_rcp_f32 v162, v162
    v_mfma_f32_32x32x16_bf16 v[176:191], v[196:199], v[108:111], v[176:191]
    v_rcp_f32 v163, v163
    v_rcp_f32 v164, v164
    v_rcp_f32 v165, v165
    v_mfma_f32_32x32x16_bf16 v[176:191], v[200:203], v[116:119], v[176:191]
    v_rcp_f32 v166, v166
    v_rcp_f32 v167, v167
    v_rcp_f32 v168, v168
    v_mfma_f32_32x32x16_bf16 v[176:191], v[204:207], v[124:127], v[176:191]
    v_rcp_f32 v169, v169
    v_rcp_f32 v170, v170
    v_rcp_f32 v171, v171
    v_rcp_f32 v172, v172
    v_rcp_f32 v173, v173
    v_rcp_f32 v174, v174
    v_rcp_f32 v175, v175
    s_nop 7
    s_setprio 0
    ds_read_b128 v[12:15], v35 offset:0
    v_mul_f32 v252, v255, v4
    v_fma_f32 v248, v251, v4, v160
    v_fmac_f32 v252, v160, v176
    v_add_f32 v248, v248, v161
    v_fmac_f32 v252, v161, v177
    v_add_f32 v248, v248, v162
    v_fmac_f32 v252, v162, v178
    v_add_f32 v248, v248, v163
    v_fmac_f32 v252, v163, v179
    v_mul_f32 v253, v252, v5
    v_fma_f32 v249, v248, v5, v164
    v_fmac_f32 v253, v164, v180
    v_add_f32 v249, v249, v165
    v_fmac_f32 v253, v165, v181
    v_add_f32 v249, v249, v166
    v_fmac_f32 v253, v166, v182
    v_add_f32 v249, v249, v167
    v_fmac_f32 v253, v167, v183
    v_mul_f32 v254, v253, v6
    v_fma_f32 v250, v249, v6, v168
    v_fmac_f32 v254, v168, v184
    v_add_f32 v250, v250, v169
    v_fmac_f32 v254, v169, v185
    v_add_f32 v250, v250, v170
    v_fmac_f32 v254, v170, v186
    v_add_f32 v250, v250, v171
    v_fmac_f32 v254, v171, v187
    v_mul_f32 v255, v254, v7
    v_fma_f32 v251, v250, v7, v172
    v_fmac_f32 v255, v172, v188
    v_add_f32 v251, v251, v173
    v_fmac_f32 v255, v173, v189
    v_add_f32 v251, v251, v174
    v_fmac_f32 v255, v174, v190
    v_add_f32 v251, v251, v175
    v_fmac_f32 v255, v175, v191
    s_and_b32 s30, s44, 15
    s_cbranch_scc1 FKQ_3S
FKQ_3:
    s_lshr_b64 s[44:45], s[44:45], 4
    s_branch FK_LOOPDONE
FK_LAST1:
    s_setprio 1
    v_mfma_f32_32x32x16_bf16 v[176:191], v[208:211], v[96:99], 0
    v_exp_f32 v160, v224
    v_exp_f32 v161, v225
    v_exp_f32 v162, v226
    v_exp_f32 v163, v227
    v_mfma_f32_32x32x16_bf16 v[176:191], v[212:215], v[104:107], v[176:191]
    v_exp_f32 v164, v228
    v_exp_f32 v165, v229
    v_exp_f32 v166, v230
    v_exp_f32 v167, v231
    v_mfma_f32_32x32x16_bf16 v[176:191], v[216:219], v[112:115], v[176:191]
    v_exp_f32 v168, v232
    v_exp_f32 v169, v233
    v_exp_f32 v170, v234
    v_exp_f32 v171, v235
    v_mfma_f32_32x32x16_bf16 v[176:191], v[220:223], v[120:123], v[176:191]
    v_exp_f32 v172, v236
    v_exp_f32 v173, v237
    v_exp_f32 v174, v238
    v_exp_f32 v175, v239
    v_rcp_f32 v144, v144
    v_rcp_f32 v145, v145
    v_rcp_f32 v146, v146
    v_rcp_f32 v147, v147
    v_rcp_f32 v148, v148
    v_rcp_f32 v149, v149
    v_rcp_f32 v150, v150
    v_rcp_f32 v151, v151
    v_rcp_f32 v152, v152
    v_rcp_f32 v153, v153
    v_rcp_f32 v154, v154
    v_rcp_f32 v155, v155
    v_rcp_f32 v156, v156
    v_rcp_f32 v157, v157
    v_rcp_f32 v158, v158
    v_rcp_f32 v159, v159
    s_setprio 0
    v_add_f32 v160, 1.0, v160
    v_add_f32 v161, 1.0, v161
    v_add_f32 v162, 1.0, v162
    v_add_f32 v163, 1.0, v163
    v_add_f32 v164, 1.0, v164
    v_add_f32 v165, 1.0, v165
    v_add_f32 v166, 1.0, v166
    v_add_f32 v167, 1.0, v167
    v_add_f32 v168, 1.0, v168
    v_add_f32 v169, 1.0, v169
    v_add_f32 v170, 1.0, v170
    v_add_f32 v171, 1.0, v171
    v_add_f32 v172, 1.0, v172
    v_add_f32 v173, 1.0, v173
    v_add_f32 v174, 1.0, v174
    v_add_f32 v175, 1.0, v175
    v_mul_f32 v244, v247, v8
    v_fma_f32 v240, v243, v8, v144
    v_fmac_f32 v244, v144, v176
    v_add_f32 v240, v240, v145
    v_fmac_f32 v244, v145, v177
    v_add_f32 v240, v240, v146
    v_fmac_f32 v244, v146, v178
    v_add_f32 v240, v240, v147
    v_fmac_f32 v244, v147, v179
    v_mul_f32 v245, v244, v9
    v_fma_f32 v241, v240, v9, v148
    v_fmac_f32 v245, v148, v180
    v_add_f32 v241, v241, v149
    v_fmac_f32 v245, v149, v181
    v_add_f32 v241, v241, v150
    v_fmac_f32 v245, v150, v182
    v_add_f32 v241, v241, v151
    v_fmac_f32 v245, v151, v183
    v_mul_f32 v246, v245, v10
    v_fma_f32 v242, v241, v10, v152
    v_fmac_f32 v246, v152, v184
    v_add_f32 v242, v242, v153
    v_fmac_f32 v246, v153, v185
    v_add_f32 v242, v242, v154
    v_fmac_f32 v246, v154, v186
    v_add_f32 v242, v242, v155
    v_fmac_f32 v246, v155, v187
    v_mul_f32 v247, v246, v11
    v_fma_f32 v243, v242, v11, v156
    v_fmac_f32 v247, v156, v188
    v_add_f32 v243, v243, v157
    v_fmac_f32 v247, v157, v189
    v_add_f32 v243, v243, v158
    v_fmac_f32 v247, v158, v190
    v_add_f32 v243, v243, v159
    v_fmac_f32 v247, v159, v191
    s_setprio 1
    v_mfma_f32_32x32x16_bf16 v[176:191], v[208:211], v[100:103], 0
    v_rcp_f32 v160, v160
    v_rcp_f32 v161, v161
    v_rcp_f32 v162, v162
    v_mfma_f32_32x32x16_bf16 v[176:191], v[212:215], v[108:111], v[176:191]
    v_rcp_f32 v163, v163
    v_rcp_f32 v164, v164
    v_rcp_f32 v165, v165
    v_mfma_f32_32x32x16_bf16 v[176:191], v[216:219], v[116:119], v[176:191]
    v_rcp_f32 v166, v166
    v_rcp_f32 v167, v167
    v_rcp_f32 v168, v168
    v_mfma_f32_32x32x16_bf16 v[176:191], v[220:223], v[124:127], v[176:191]
    v_rcp_f32 v169, v169
    v_rcp_f32 v170, v170
    v_rcp_f32 v171, v171
    v_rcp_f32 v172, v172
    v_rcp_f32 v173, v173
    v_rcp_f32 v174, v174
    v_rcp_f32 v175, v175
    s_nop 7
    s_setprio 0
    ds_read_b128 v[12:15], v35 offset:0
    v_mul_f32 v252, v255, v8
    v_fma_f32 v248, v251, v8, v160
    v_fmac_f32 v252, v160, v176
    v_add_f32 v248, v248, v161
    v_fmac_f32 v252, v161, v177
    v_add_f32 v248, v248, v162
    v_fmac_f32 v252, v162, v178
    v_add_f32 v248, v248, v163
    v_fmac_f32 v252, v163, v179
    v_mul_f32 v253, v252, v9
    v_fma_f32 v249, v248, v9, v164
    v_fmac_f32 v253, v164, v180
    v_add_f32 v249, v249, v165
    v_fmac_f32 v253, v165, v181
    v_add_f32 v249, v249, v166
    v_fmac_f32 v253, v166, v182
    v_add_f32 v249, v249, v167
    v_fmac_f32 v253, v167, v183
    v_mul_f32 v254, v253, v10
    v_fma_f32 v250, v249, v10, v168
    v_fmac_f32 v254, v168, v184
    v_add_f32 v250, v250, v169
    v_fmac_f32 v254, v169, v185
    v_add_f32 v250, v250, v170
    v_fmac_f32 v254, v170, v186
    v_add_f32 v250, v250, v171
    v_fmac_f32 v254, v171, v187
    v_mul_f32 v255, v254, v11
    v_fma_f32 v251, v250, v11, v172
    v_fmac_f32 v255, v172, v188
    v_add_f32 v251, v251, v173
    v_fmac_f32 v255, v173, v189
    v_add_f32 v251, v251, v174
    v_fmac_f32 v255, v174, v190
    v_add_f32 v251, v251, v175
    v_fmac_f32 v255, v175, v191
    s_and_b32 s30, s44, 15
    s_cbranch_scc1 FKQ_4S
FKQ_4:
    s_lshr_b64 s[44:45], s[44:45], 4
    s_branch FK_LOOPDONE
FKQ_3S:
    s_waitcnt lgkmcnt(0)
    s_bitcmp1_b32 s44, 0
    s_cbranch_scc0 FKQ_3_0
    v_add_u32 v37, v12, v36
    ds_write2_b32 v37, v240, v248 offset0:0 offset1:32
    ds_write2_b32 v37, v244, v252 offset0:64 offset1:96
FKQ_3_0:
    s_bitcmp1_b32 s44, 1
    s_cbranch_scc0 FKQ_3_1
    v_add_u32 v37, v13, v36
    ds_write2_b32 v37, v241, v249 offset0:0 offset1:32
    ds_write2_b32 v37, v245, v253 offset0:64 offset1:96
FKQ_3_1:
    s_bitcmp1_b32 s44, 2
    s_cbranch_scc0 FKQ_3_2
    v_add_u32 v37, v14, v36
    ds_write2_b32 v37, v242, v250 offset0:0 offset1:32
    ds_write2_b32 v37, v246, v254 offset0:64 offset1:96
FKQ_3_2:
    s_bitcmp1_b32 s44, 3
    s_cbranch_scc0 FKQ_3_3
    v_add_u32 v37, v15, v36
    ds_write2_b32 v37, v243, v251 offset0:0 offset1:32
    ds_write2_b32 v37, v247, v255 offset0:64 offset1:96
FKQ_3_3:
    s_branch FKQ_3
FKQ_4S:
    s_waitcnt lgkmcnt(0)
    s_bitcmp1_b32 s44, 0
    s_cbranch_scc0 FKQ_4_0
    v_add_u32 v37, v12, v36
    ds_write2_b32 v37, v240, v248 offset0:0 offset1:32
    ds_write2_b32 v37, v244, v252 offset0:64 offset1:96
FKQ_4_0:
    s_bitcmp1_b32 s44, 1
    s_cbranch_scc0 FKQ_4_1
    v_add_u32 v37, v13, v36
    ds_write2_b32 v37, v241, v249 offset0:0 offset1:32
    ds_write2_b32 v37, v245, v253 offset0:64 offset1:96
FKQ_4_1:
    s_bitcmp1_b32 s44, 2
    s_cbranch_scc0 FKQ_4_2
    v_add_u32 v37, v14, v36
    ds_write2_b32 v37, v242, v250 offset0:0 offset1:32
    ds_write2_b32 v37, v246, v254 offset0:64 offset1:96
FKQ_4_2:
    s_bitcmp1_b32 s44, 3
    s_cbranch_scc0 FKQ_4_3
    v_add_u32 v37, v15, v36
    ds_write2_b32 v37, v243, v251 offset0:0 offset1:32
    ds_write2_b32 v37, v247, v255 offset0:64 offset1:96
FKQ_4_3:
    s_branch FKQ_4
FK_LOOPDONE:
    s_setprio 0
    v_lshlrev_b32 v20, 4, v0
    s_mul_i32 s26, s70, 12544
    v_add_u32 v20, s26, v20
    v_add_u32 v21, 8192, v20
    v_lshrrev_b32 v22, 3, v0
    v_lshlrev_b32 v22, 7, v22
    v_and_b32 v23, 3, v0
    v_lshl_add_u32 v22, v23, 5, v22
    s_lshl_b32 s27, s2, 14
    s_add_u32 s27, s27, 12582912
    s_add_u32 s28, s27, 8192
    v_cmp_gt_u32 vcc, 272, v0
    s_mov_b64 s[34:35], vcc
    buffer_load_dwordx4 v[128:131], v20, s[4:7], 0 offen
    buffer_load_dwordx4 v[136:139], v22, s[12:15], s27 offen
    buffer_load_dwordx4 v[140:143], v22, s[12:15], s27 offen offset:16
    s_mov_b64 exec, s[34:35]
    buffer_load_dwordx4 v[132:135], v21, s[4:7], 0 offen
    buffer_load_dwordx4 v[224:227], v22, s[12:15], s28 offen
    buffer_load_dwordx4 v[228:231], v22, s[12:15], s28 offen offset:16
    s_mov_b64 exec, -1
    v_and_b32 v23, 7, v0
    v_and_b32 v22, 4, v0
    v_lshlrev_b32 v22, 2, v22
    v_sub_u32 v22, 16, v22
    v_lshlrev_b32 v23, 5, v23
    v_lshrrev_b32 v4, 3, v0
    v_lshlrev_b32 v5, 2, v4
    v_add_u32 v5, 72960, v5
    ds_read_b32 v9, v5
    v_lshrrev_b32 v10, 3, v0
    v_add_u32 v10, 64, v10
    v_lshlrev_b32 v11, 2, v10
    v_add_u32 v11, 72960, v11
    ds_read_b32 v15, v11
    v_mov_b32 v37, 113
    s_waitcnt lgkmcnt(0)
    v_cmp_eq_u32 s[36:37], 0, v9
    s_nop 1
    v_cndmask_b32_e64 v4, v4, v37, s[36:37]
    v_mul_u32_u24 v4, 640, v4
    v_add_u32 v4, v4, v23
    v_cmp_eq_u32 s[36:37], 0, v15
    s_nop 1
    v_cndmask_b32_e64 v10, v10, v37, s[36:37]
    v_mul_u32_u24 v10, 640, v10
    v_add_u32 v10, v10, v23
    s_barrier
    ds_read_b32 v6, v5 offset:512
    ds_read_b32 v7, v5 offset:1040
    s_mov_b64 exec, s[34:35]
    ds_read_b32 v12, v11 offset:512
    ds_read_b32 v13, v11 offset:1040
    s_mov_b64 exec, -1
    ds_read_b128 v[144:147], v4
    ds_read_b128 v[148:151], v4 offset:16
    ds_read_b128 v[152:155], v4 offset:256
    ds_read_b128 v[156:159], v4 offset:272
    s_mov_b64 exec, s[34:35]
    ds_read_b128 v[176:179], v10
    ds_read_b128 v[180:183], v10 offset:16
    ds_read_b128 v[184:187], v10 offset:256
    ds_read_b128 v[188:191], v10 offset:272
    s_waitcnt lgkmcnt(8)
    s_mov_b64 exec, -1
FK_PL0:
    v_cmp_le_u32 s[36:37], v7, v6
    s_nop 1
    v_cndmask_b32_e64 v9, v37, v7, s[36:37]
    v_mul_u32_u24 v9, 640, v9
    v_add_u32 v9, v9, v23
    ds_read_b128 v[160:163], v9
    ds_read_b128 v[164:167], v9 offset:16
    ds_read_b128 v[168:171], v9 offset:256
    ds_read_b128 v[172:175], v9 offset:272
    v_add_u32 v7, 1, v7
    v_cmp_le_u32 vcc, v7, v6
    s_waitcnt lgkmcnt(0)
    v_add_f32 v144, v144, v160
    v_add_f32 v145, v145, v161
    v_add_f32 v146, v146, v162
    v_add_f32 v147, v147, v163
    v_add_f32 v148, v148, v164
    v_add_f32 v149, v149, v165
    v_add_f32 v150, v150, v166
    v_add_f32 v151, v151, v167
    v_add_f32 v152, v152, v168
    v_add_f32 v153, v153, v169
    v_add_f32 v154, v154, v170
    v_add_f32 v155, v155, v171
    v_add_f32 v156, v156, v172
    v_add_f32 v157, v157, v173
    v_add_f32 v158, v158, v174
    v_add_f32 v159, v159, v175
    s_cbranch_vccnz FK_PL0
    s_cmp_eq_u32 s18, 0
    s_cbranch_scc1 FK_NOSLOW0
    s_mul_i32 s26, s2, 50176
    s_add_u32 s26, s26, 20971520
    v_lshlrev_b32 v9, 6, v0
    s_cmp_eq_u32 s16, 0
    s_cbranch_scc1 FK_NOLD0
    buffer_load_dwordx4 v[160:163], v9, s[12:15], s26 offen offset:0 sc1
    buffer_load_dwordx4 v[164:167], v9, s[12:15], s26 offen offset:16 sc1
    buffer_load_dwordx4 v[168:171], v9, s[12:15], s26 offen offset:32 sc1
    buffer_load_dwordx4 v[172:175], v9, s[12:15], s26 offen offset:48 sc1
    s_waitcnt vmcnt(0)
    v_add_f32 v144, v144, v160
    v_add_f32 v145, v145, v161
    v_add_f32 v146, v146, v162
    v_add_f32 v147, v147, v163
    v_add_f32 v148, v148, v164
    v_add_f32 v149, v149, v165
    v_add_f32 v150, v150, v166
    v_add_f32 v151, v151, v167
    v_add_f32 v152, v152, v168
    v_add_f32 v153, v153, v169
    v_add_f32 v154, v154, v170
    v_add_f32 v155, v155, v171
    v_add_f32 v156, v156, v172
    v_add_f32 v157, v157, v173
    v_add_f32 v158, v158, v174
    v_add_f32 v159, v159, v175
FK_NOLD0:
    buffer_store_dwordx4 v[144:147], v9, s[12:15], s26 offen offset:0 sc1
    buffer_store_dwordx4 v[148:151], v9, s[12:15], s26 offen offset:16 sc1
    buffer_store_dwordx4 v[152:155], v9, s[12:15], s26 offen offset:32 sc1
    buffer_store_dwordx4 v[156:159], v9, s[12:15], s26 offen offset:48 sc1
    s_waitcnt vmcnt(0)
FK_NOSLOW0:
    v_add_f32 v144, 0x358637bd, v144
    v_add_f32 v145, 0x358637bd, v145
    v_add_f32 v146, 0x358637bd, v146
    v_add_f32 v147, 0x358637bd, v147
    v_add_f32 v148, 0x358637bd, v148
    v_add_f32 v149, 0x358637bd, v149
    v_add_f32 v150, 0x358637bd, v150
    v_add_f32 v151, 0x358637bd, v151
    v_rcp_f32 v144, v144
    v_rcp_f32 v145, v145
    v_rcp_f32 v146, v146
    v_rcp_f32 v147, v147
    v_rcp_f32 v148, v148
    v_rcp_f32 v149, v149
    v_rcp_f32 v150, v150
    v_rcp_f32 v151, v151
    s_waitcnt vmcnt(3)
    v_lshlrev_b32 v136, v22, v136
    v_lshlrev_b32 v137, v22, v137
    v_lshlrev_b32 v138, v22, v138
    v_lshlrev_b32 v139, v22, v139
    v_lshlrev_b32 v140, v22, v140
    v_lshlrev_b32 v141, v22, v141
    v_lshlrev_b32 v142, v22, v142
    v_lshlrev_b32 v143, v22, v143
    v_and_b32 v136, 0xffff0000, v136
    v_and_b32 v137, 0xffff0000, v137
    v_and_b32 v138, 0xffff0000, v138
    v_and_b32 v139, 0xffff0000, v139
    v_and_b32 v140, 0xffff0000, v140
    v_and_b32 v141, 0xffff0000, v141
    v_and_b32 v142, 0xffff0000, v142
    v_and_b32 v143, 0xffff0000, v143
    v_fma_f32 v144, v144, v152, v136
    v_fma_f32 v145, v145, v153, v137
    v_fma_f32 v146, v146, v154, v138
    v_fma_f32 v147, v147, v155, v139
    v_fma_f32 v148, v148, v156, v140
    v_fma_f32 v149, v149, v157, v141
    v_fma_f32 v150, v150, v158, v142
    v_fma_f32 v151, v151, v159, v143
    v_lshlrev_b32 v152, 16, v128
    v_and_b32 v153, 0xffff0000, v128
    v_lshlrev_b32 v154, 16, v129
    v_and_b32 v155, 0xffff0000, v129
    v_lshlrev_b32 v156, 16, v130
    v_and_b32 v157, 0xffff0000, v130
    v_lshlrev_b32 v158, 16, v131
    v_and_b32 v159, 0xffff0000, v131
    v_max_f32 v144, 0, v144
    v_max_f32 v145, 0, v145
    v_max_f32 v146, 0, v146
    v_max_f32 v147, 0, v147
    v_max_f32 v148, 0, v148
    v_max_f32 v149, 0, v149
    v_max_f32 v150, 0, v150
    v_max_f32 v151, 0, v151
    v_add_f32 v144, v144, v152
    v_add_f32 v145, v145, v153
    v_add_f32 v146, v146, v154
    v_add_f32 v147, v147, v155
    v_add_f32 v148, v148, v156
    v_add_f32 v149, v149, v157
    v_add_f32 v150, v150, v158
    v_add_f32 v151, v151, v159
    v_cvt_pk_bf16_f32 v152, v144, v145
    v_cvt_pk_bf16_f32 v153, v146, v147
    v_cvt_pk_bf16_f32 v154, v148, v149
    v_cvt_pk_bf16_f32 v155, v150, v151
    buffer_store_dwordx4 v[152:155], v20, s[8:11], 0 offen sc1
    s_cmp_eq_u64 s[34:35], 0
    s_cbranch_scc1 FK_FIN
    s_mov_b64 exec, s[34:35]
FK_PL1:
    v_cmp_le_u32 s[36:37], v13, v12
    s_nop 1
    v_cndmask_b32_e64 v15, v37, v13, s[36:37]
    v_mul_u32_u24 v15, 640, v15
    v_add_u32 v15, v15, v23
    ds_read_b128 v[192:195], v15
    ds_read_b128 v[196:199], v15 offset:16
    ds_read_b128 v[200:203], v15 offset:256
    ds_read_b128 v[204:207], v15 offset:272
    v_add_u32 v13, 1, v13
    v_cmp_le_u32 vcc, v13, v12
    s_waitcnt lgkmcnt(0)
    v_add_f32 v176, v176, v192
    v_add_f32 v177, v177, v193
    v_add_f32 v178, v178, v194
    v_add_f32 v179, v179, v195
    v_add_f32 v180, v180, v196
    v_add_f32 v181, v181, v197
    v_add_f32 v182, v182, v198
    v_add_f32 v183, v183, v199
    v_add_f32 v184, v184, v200
    v_add_f32 v185, v185, v201
    v_add_f32 v186, v186, v202
    v_add_f32 v187, v187, v203
    v_add_f32 v188, v188, v204
    v_add_f32 v189, v189, v205
    v_add_f32 v190, v190, v206
    v_add_f32 v191, v191, v207
    s_cbranch_vccnz FK_PL1
    s_cmp_eq_u32 s18, 0
    s_cbranch_scc1 FK_NOSLOW1
    s_mul_i32 s26, s2, 50176
    s_add_u32 s26, s26, 21004288
    v_lshlrev_b32 v15, 6, v0
    s_cmp_eq_u32 s16, 0
    s_cbranch_scc1 FK_NOLD1
    buffer_load_dwordx4 v[192:195], v15, s[12:15], s26 offen offset:0 sc1
    buffer_load_dwordx4 v[196:199], v15, s[12:15], s26 offen offset:16 sc1
    buffer_load_dwordx4 v[200:203], v15, s[12:15], s26 offen offset:32 sc1
    buffer_load_dwordx4 v[204:207], v15, s[12:15], s26 offen offset:48 sc1
    s_waitcnt vmcnt(0)
    v_add_f32 v176, v176, v192
    v_add_f32 v177, v177, v193
    v_add_f32 v178, v178, v194
    v_add_f32 v179, v179, v195
    v_add_f32 v180, v180, v196
    v_add_f32 v181, v181, v197
    v_add_f32 v182, v182, v198
    v_add_f32 v183, v183, v199
    v_add_f32 v184, v184, v200
    v_add_f32 v185, v185, v201
    v_add_f32 v186, v186, v202
    v_add_f32 v187, v187, v203
    v_add_f32 v188, v188, v204
    v_add_f32 v189, v189, v205
    v_add_f32 v190, v190, v206
    v_add_f32 v191, v191, v207
FK_NOLD1:
    buffer_store_dwordx4 v[176:179], v15, s[12:15], s26 offen offset:0 sc1
    buffer_store_dwordx4 v[180:183], v15, s[12:15], s26 offen offset:16 sc1
    buffer_store_dwordx4 v[184:187], v15, s[12:15], s26 offen offset:32 sc1
    buffer_store_dwordx4 v[188:191], v15, s[12:15], s26 offen offset:48 sc1
    s_waitcnt vmcnt(0)
FK_NOSLOW1:
    v_add_f32 v176, 0x358637bd, v176
    v_add_f32 v177, 0x358637bd, v177
    v_add_f32 v178, 0x358637bd, v178
    v_add_f32 v179, 0x358637bd, v179
    v_add_f32 v180, 0x358637bd, v180
    v_add_f32 v181, 0x358637bd, v181
    v_add_f32 v182, 0x358637bd, v182
    v_add_f32 v183, 0x358637bd, v183
    v_rcp_f32 v176, v176
    v_rcp_f32 v177, v177
    v_rcp_f32 v178, v178
    v_rcp_f32 v179, v179
    v_rcp_f32 v180, v180
    v_rcp_f32 v181, v181
    v_rcp_f32 v182, v182
    v_rcp_f32 v183, v183
    s_waitcnt vmcnt(1)
    v_lshlrev_b32 v224, v22, v224
    v_lshlrev_b32 v225, v22, v225
    v_lshlrev_b32 v226, v22, v226
    v_lshlrev_b32 v227, v22, v227
    v_lshlrev_b32 v228, v22, v228
    v_lshlrev_b32 v229, v22, v229
    v_lshlrev_b32 v230, v22, v230
    v_lshlrev_b32 v231, v22, v231
    v_and_b32 v224, 0xffff0000, v224
    v_and_b32 v225, 0xffff0000, v225
    v_and_b32 v226, 0xffff0000, v226
    v_and_b32 v227, 0xffff0000, v227
    v_and_b32 v228, 0xffff0000, v228
    v_and_b32 v229, 0xffff0000, v229
    v_and_b32 v230, 0xffff0000, v230
    v_and_b32 v231, 0xffff0000, v231
    v_fma_f32 v176, v176, v184, v224
    v_fma_f32 v177, v177, v185, v225
    v_fma_f32 v178, v178, v186, v226
    v_fma_f32 v179, v179, v187, v227
    v_fma_f32 v180, v180, v188, v228
    v_fma_f32 v181, v181, v189, v229
    v_fma_f32 v182, v182, v190, v230
    v_fma_f32 v183, v183, v191, v231
    v_lshlrev_b32 v184, 16, v132
    v_and_b32 v185, 0xffff0000, v132
    v_lshlrev_b32 v186, 16, v133
    v_and_b32 v187, 0xffff0000, v133
    v_lshlrev_b32 v188, 16, v134
    v_and_b32 v189, 0xffff0000, v134
    v_lshlrev_b32 v190, 16, v135
    v_and_b32 v191, 0xffff0000, v135
    v_max_f32 v176, 0, v176
    v_max_f32 v177, 0, v177
    v_max_f32 v178, 0, v178
    v_max_f32 v179, 0, v179
    v_max_f32 v180, 0, v180
    v_max_f32 v181, 0, v181
    v_max_f32 v182, 0, v182
    v_max_f32 v183, 0, v183
    v_add_f32 v176, v176, v184
    v_add_f32 v177, v177, v185
    v_add_f32 v178, v178, v186
    v_add_f32 v179, v179, v187
    v_add_f32 v180, v180, v188
    v_add_f32 v181, v181, v189
    v_add_f32 v182, v182, v190
    v_add_f32 v183, v183, v191
    v_cvt_pk_bf16_f32 v184, v176, v177
    v_cvt_pk_bf16_f32 v185, v178, v179
    v_cvt_pk_bf16_f32 v186, v180, v181
    v_cvt_pk_bf16_f32 v187, v182, v183
    buffer_store_dwordx4 v[184:187], v21, s[8:11], 0 offen sc1
FK_FIN:
    s_mov_b64 exec, -1
    s_cmp_eq_u32 s18, 0
    s_cbranch_scc1 FK_END
    s_add_u32 s16, s16, 6
    s_add_u32 s17, s17, 6
    s_cmp_ge_u32 s16, s19
    s_cbranch_scc1 FK_END
FK_REBATCH:
    s_waitcnt vmcnt(0) lgkmcnt(0)
    s_barrier
    v_mov_b32 v4, 0
    v_mov_b32 v5, 0
    v_mov_b32 v6, 0
    v_mov_b32 v7, 0
    v_mov_b32 v8, 0x10000
    v_mov_b32 v9, 0x10000
    v_add_u32 v11, 74000, v62
    ds_write_b64 v11, v[8:9]
    s_lshl_b32 s30, s3, 6
    s_add_u32 s30, s30, 74512
    v_lshl_add_u32 v11, v1, 2, s30
    v_lshlrev_b32 v10, 4, v0
    v_add_u32 v10, 72320, v10
    v_cmp_gt_u32 vcc, 105, v0
    s_mov_b64 exec, 0xffff
    ds_write_b32 v11, v4
    s_and_b64 exec, vcc, vcc
    ds_write_b128 v10, v[4:7]
    s_mov_b64 exec, -1
    s_lshl_b32 s26, s70, 3
    s_add_u32 s26, s26, 65536
    v_mov_b32 v38, s93
    s_mov_b32 s67, 1
    s_waitcnt lgkmcnt(0)
    s_barrier
    s_branch FK_XAD
FK_END:
    s_endpgm
.section .rodata,"a"
.p2align 6
.amdhsa_kernel gather_scatter__edge_featured_mpnn_gatedgcn__graph_kernel
.amdhsa_next_free_vgpr 256
.amdhsa_next_free_sgpr 102
.amdhsa_accum_offset 256
.amdhsa_group_segment_fixed_size 0
.amdhsa_kernarg_size 96
.amdhsa_user_sgpr_count 2
.amdhsa_user_sgpr_kernarg_segment_ptr 1
.amdhsa_system_sgpr_workgroup_id_x 1
.end_amdhsa_kernel
```
